```python
import torch

def _softmax(x, axis=-1):
    return torch.softmax(x, dim=axis)
def _gelu(x):
    return torch.nn.functional.gelu(x, approximate="tanh")
def _silu(x):
    return torch.nn.functional.silu(x)
def _sigmoid(x):
    return torch.sigmoid(x)
def _layernorm(x, axis=-1, eps=1e-5):
    m = x.mean(dim=axis, keepdim=True)
    v = x.var(dim=axis, keepdim=True, unbiased=False)
    return (x - m) / torch.sqrt(v + eps)
def _scatter_add(tgt, idx, src, axis=0):
    return tgt.clone().index_add_(axis, idx, src)
def _segment_sum(src, seg, n):
    out = torch.zeros((n,) + src.shape[1:], dtype=src.dtype)
    return out.index_add_(0, seg, src)
def _pad(x, pw):
    flat = tuple(v for pair in reversed(pw) for v in pair)
    return torch.nn.functional.pad(x, flat)

kernel_name = 'concat_heads__gqa_block_cached__gqa_block_cached__near_ridge'

def setup_inputs():

    _w = (lambda a: (lambda t: t.to(torch.bfloat16) if t.is_floating_point() else t)(torch.as_tensor(a)))
    def _A_setup():
        B, Sq, D = 16, 48, 448
        Hq, Hkv, Sk, Dh = 16, 8, 48, 256
        assert Hq % Hkv == 0, (Hq, Hkv)
        return {
            "x": _w((lambda *s: torch.randn(*s, dtype=torch.bfloat16) * 0.8)(B, Sq, D)),
            "k_cache": _w((lambda *s: torch.randn(*s, dtype=torch.bfloat16) * 0.8)(B, Hkv, Sk, Dh)),
            "v_cache": _w((lambda *s: torch.randn(*s, dtype=torch.bfloat16) * 0.05)(B, Hkv, Sk, Dh)),
            "wq": _w((lambda *s: torch.randn(*s, dtype=torch.bfloat16) * 0.8)(D, Hq * Dh) * (D ** -0.5)),
            "wo": _w((lambda *s: torch.randn(*s, dtype=torch.bfloat16) * 0.05)(Hq * Dh, D) * ((Hq * Dh) ** -0.5)),
        }
    _A_in = _A_setup()

    def _B_setup():
        B, Sq, D = 16, 48, 448
        Hq, Hkv, Sk, Dh = 16, 8, 48, 256
        assert Hq % Hkv == 0, (Hq, Hkv)
        return {
            "x": _w((lambda *s: torch.randn(*s, dtype=torch.bfloat16) * 0.8)(B, Sq, D)),
            "k_cache": _w((lambda *s: torch.randn(*s, dtype=torch.bfloat16) * 0.8)(B, Hkv, Sk, Dh)),
            "v_cache": _w((lambda *s: torch.randn(*s, dtype=torch.bfloat16) * 0.05)(B, Hkv, Sk, Dh)),
            "wq": _w((lambda *s: torch.randn(*s, dtype=torch.bfloat16) * 0.8)(D, Hq * Dh) * (D ** -0.5)),
            "wo": _w((lambda *s: torch.randn(*s, dtype=torch.bfloat16) * 0.05)(Hq * Dh, D) * ((Hq * Dh) ** -0.5)),
        }
    _B_in = _B_setup()

    return {
        "A_x": _A_in["x"],
        "A_k_cache": _A_in["k_cache"],
        "A_v_cache": _A_in["v_cache"],
        "A_wq": _A_in["wq"],
        "A_wo": _A_in["wo"],
        "B_x": _B_in["x"],
        "B_k_cache": _B_in["k_cache"],
        "B_v_cache": _B_in["v_cache"],
        "B_wq": _B_in["wq"],
        "B_wo": _B_in["wo"],
    }

def reference(A_x, A_k_cache, A_v_cache, A_wq, A_wo, B_x, B_k_cache, B_v_cache, B_wq, B_wo):
    def _A_ref(x, k_cache, v_cache, wq, wo):
        B, Sq, D = x.shape
        Hq, Dh = 16, 256
        Hkv = k_cache.shape[1]
        rep = Hq // Hkv
        q = (lambda x, *d: x.permute(*d))((x @ wq).reshape(B, Sq, Hq, Dh), 0, 2, 1, 3)
        k = (lambda x, n, axis: torch.repeat_interleave(x, n, dim=axis))(k_cache, rep, axis=1)
        v = (lambda x, n, axis: torch.repeat_interleave(x, n, dim=axis))(v_cache, rep, axis=1)
        scores = torch.einsum("bhqd,bhkd->bhqk", q, k) * (Dh ** -0.5)
        p = _softmax(scores, axis=-1)
        o = torch.einsum("bhqk,bhkd->bhqd", p, v)
        return (lambda x, *d: x.permute(*d))(o, 0, 2, 1, 3).reshape(B, Sq, Hq * Dh) @ wo

    def _B_ref(x, k_cache, v_cache, wq, wo):
        B, Sq, D = x.shape
        Hq, Dh = 16, 256
        Hkv = k_cache.shape[1]
        rep = Hq // Hkv
        q = (lambda x, *d: x.permute(*d))((x @ wq).reshape(B, Sq, Hq, Dh), 0, 2, 1, 3)
        k = (lambda x, n, axis: torch.repeat_interleave(x, n, dim=axis))(k_cache, rep, axis=1)
        v = (lambda x, n, axis: torch.repeat_interleave(x, n, dim=axis))(v_cache, rep, axis=1)
        scores = torch.einsum("bhqd,bhkd->bhqk", q, k) * (Dh ** -0.5)
        p = _softmax(scores, axis=-1)
        o = torch.einsum("bhqk,bhkd->bhqd", p, v)
        return (lambda x, *d: x.permute(*d))(o, 0, 2, 1, 3).reshape(B, Sq, Hq * Dh) @ wo

    a = _A_ref(A_x, A_k_cache, A_v_cache, A_wq, A_wo)
    b = _B_ref(B_x, B_k_cache, B_v_cache, B_wq, B_wo)
    return torch.concatenate([a, b], axis=-1)
```

```asm
; @launch kernel=attn_kernel grid=(256,1,1) block=(512,1,1) lds=163840
; @launch kernel=oproj_kernel grid=(224,1,1) block=(512,1,1) lds=131072
.amdgcn_target "amdgcn-amd-amdhsa--gfx950"
.text
.p2align 8
.globl attn_kernel
.type attn_kernel,@function
attn_kernel:
  s_cmp_ge_u32 s2, 256
  s_cbranch_scc1 K1_END
  s_and_b32 s64, s2, 7
  s_lshr_b32 s65, s2, 3
  s_and_b32 s32, s64, 1
  s_lshl_b32 s32, s32, 3
  s_and_b32 s29, s65, 7
  s_add_u32 s32, s32, s29
  s_lshr_b32 s28, s32, 1
  s_lshr_b32 s30, s64, 1
  s_lshl_b32 s30, s30, 1
  s_bfe_u32 s29, s65, 0x10003
  s_add_u32 s30, s30, s29
  s_lshr_b32 s31, s65, 4
  s_mul_i32 s33, s31, 40
  s_load_dwordx8 s[36:43], s[0:1], s33
  s_load_dwordx2 s[44:45], s[0:1], 96
  s_lshr_b32 s57, s64, 2
  s_mul_i32 s57, s57, 40
  s_load_dwordx2 s[58:59], s[0:1], s57 offset:32
  v_mov_b32 v140, v0
  v_lshrrev_b32 v1, 6, v0
  v_and_b32 v0, 63, v0
  v_readfirstlane_b32 s34, v1
  s_waitcnt lgkmcnt(0)
  s_mov_b32 s8, s36
  s_mov_b32 s9, s37
  s_mov_b32 s10, 688128
  s_mov_b32 s11, 0x00020000
  s_mov_b32 s16, s38
  s_mov_b32 s17, s39
  s_mov_b32 s18, 3145728
  s_mov_b32 s19, 0x00020000
  s_mov_b32 s20, s40
  s_mov_b32 s21, s41
  s_mov_b32 s22, 3145728
  s_mov_b32 s23, 0x00020000
  s_mov_b32 s12, s42
  s_mov_b32 s13, s43
  s_mov_b32 s14, 3670016
  s_mov_b32 s15, 0x00020000
  s_mov_b32 s24, s44
  s_mov_b32 s25, s45
  s_mov_b32 s26, 12582912
  s_mov_b32 s27, 0x00020000
  s_mov_b32 s60, s58
  s_mov_b32 s61, s59
  s_mov_b32 s62, 3670016
  s_mov_b32 s63, 0x00020000
  v_and_b32 v2, 15, v0
  v_lshrrev_b32 v3, 4, v0
  v_lshrrev_b32 v4, 5, v0
  v_and_b32 v5, 31, v0
  s_mul_i32 s35, s34, 12
  s_lshl_b32 s46, s30, 1
  s_lshl_b32 s46, s46, 3
  s_add_u32 s46, s46, s28
  s_mul_i32 s46, s46, 24576
  v_add_u32 v6, s35, v4
  v_cmp_le_u32 vcc, 48, v6
  v_subrev_u32 v7, 48, v6
  s_nop 0
  v_cndmask_b32 v7, v6, v7, vcc
  v_mov_b32 v8, 0
  v_mov_b32 v9, 196608
  v_cndmask_b32 v8, v8, v9, vcc
  v_and_b32 v9, 15, v7
  v_xor_b32 v9, v5, v9
  v_lshlrev_b32 v9, 4, v9
  v_lshl_add_u32 v9, v7, 9, v9
  v_add_u32 v9, v9, v8
  s_mul_i32 s47, s34, 6144
  s_add_u32 s47, s47, 0
  s_mov_b32 m0, s47
  s_nop 0
  buffer_load_dwordx4 v9, s[16:19], s46 offen lds
  v_add_u32 v6, s35, v4
  v_add_u32 v6, 2, v6
  v_cmp_le_u32 vcc, 48, v6
  v_subrev_u32 v7, 48, v6
  s_nop 0
  v_cndmask_b32 v7, v6, v7, vcc
  v_mov_b32 v8, 0
  v_mov_b32 v9, 196608
  v_cndmask_b32 v8, v8, v9, vcc
  v_and_b32 v9, 15, v7
  v_xor_b32 v9, v5, v9
  v_lshlrev_b32 v9, 4, v9
  v_lshl_add_u32 v9, v7, 9, v9
  v_add_u32 v9, v9, v8
  s_mul_i32 s47, s34, 6144
  s_add_u32 s47, s47, 1024
  s_mov_b32 m0, s47
  s_nop 0
  buffer_load_dwordx4 v9, s[16:19], s46 offen lds
  v_add_u32 v6, s35, v4
  v_add_u32 v6, 4, v6
  v_cmp_le_u32 vcc, 48, v6
  v_subrev_u32 v7, 48, v6
  s_nop 0
  v_cndmask_b32 v7, v6, v7, vcc
  v_mov_b32 v8, 0
  v_mov_b32 v9, 196608
  v_cndmask_b32 v8, v8, v9, vcc
  v_and_b32 v9, 15, v7
  v_xor_b32 v9, v5, v9
  v_lshlrev_b32 v9, 4, v9
  v_lshl_add_u32 v9, v7, 9, v9
  v_add_u32 v9, v9, v8
  s_mul_i32 s47, s34, 6144
  s_add_u32 s47, s47, 2048
  s_mov_b32 m0, s47
  s_nop 0
  buffer_load_dwordx4 v9, s[16:19], s46 offen lds
  v_add_u32 v6, s35, v4
  v_add_u32 v6, 6, v6
  v_cmp_le_u32 vcc, 48, v6
  v_subrev_u32 v7, 48, v6
  s_nop 0
  v_cndmask_b32 v7, v6, v7, vcc
  v_mov_b32 v8, 0
  v_mov_b32 v9, 196608
  v_cndmask_b32 v8, v8, v9, vcc
  v_and_b32 v9, 15, v7
  v_xor_b32 v9, v5, v9
  v_lshlrev_b32 v9, 4, v9
  v_lshl_add_u32 v9, v7, 9, v9
  v_add_u32 v9, v9, v8
  s_mul_i32 s47, s34, 6144
  s_add_u32 s47, s47, 3072
  s_mov_b32 m0, s47
  s_nop 0
  buffer_load_dwordx4 v9, s[16:19], s46 offen lds
  v_add_u32 v6, s35, v4
  v_add_u32 v6, 8, v6
  v_cmp_le_u32 vcc, 48, v6
  v_subrev_u32 v7, 48, v6
  s_nop 0
  v_cndmask_b32 v7, v6, v7, vcc
  v_mov_b32 v8, 0
  v_mov_b32 v9, 196608
  v_cndmask_b32 v8, v8, v9, vcc
  v_and_b32 v9, 15, v7
  v_xor_b32 v9, v5, v9
  v_lshlrev_b32 v9, 4, v9
  v_lshl_add_u32 v9, v7, 9, v9
  v_add_u32 v9, v9, v8
  s_mul_i32 s47, s34, 6144
  s_add_u32 s47, s47, 4096
  s_mov_b32 m0, s47
  s_nop 0
  buffer_load_dwordx4 v9, s[16:19], s46 offen lds
  v_add_u32 v6, s35, v4
  v_add_u32 v6, 10, v6
  v_cmp_le_u32 vcc, 48, v6
  v_subrev_u32 v7, 48, v6
  s_nop 0
  v_cndmask_b32 v7, v6, v7, vcc
  v_mov_b32 v8, 0
  v_mov_b32 v9, 196608
  v_cndmask_b32 v8, v8, v9, vcc
  v_and_b32 v9, 15, v7
  v_xor_b32 v9, v5, v9
  v_lshlrev_b32 v9, 4, v9
  v_lshl_add_u32 v9, v7, 9, v9
  v_add_u32 v9, v9, v8
  s_mul_i32 s47, s34, 6144
  s_add_u32 s47, s47, 5120
  s_mov_b32 m0, s47
  s_nop 0
  buffer_load_dwordx4 v9, s[16:19], s46 offen lds
  s_cmp_ge_u32 s34, 6
  s_cselect_b32 s47, 6, 0
  s_sub_u32 s47, s34, s47
  s_lshl_b32 s48, s47, 4
  v_lshrrev_b32 v4, 2, v0
  v_and_b32 v5, 3, v0
  v_bfe_u32 v6, v4, 1, 2
  v_xor_b32 v5, v5, v6
  s_mul_i32 s49, s30, 96
  s_add_u32 s49, s49, s48
  v_add_u32 v4, s49, v4
  v_mul_u32_u24 v4, 896, v4
  v_lshl_add_u32 v10, v5, 4, v4
  s_lshl_b32 s48, s48, 6
  v_lshrrev_b32 v4, 5, v0
  v_and_b32 v5, 31, v0
  s_lshl_b32 s50, s34, 2
  v_add_u32 v6, s50, v4
  v_and_b32 v7, 3, v6
  v_bfe_u32 v8, v6, 3, 1
  v_lshl_or_b32 v7, v8, 2, v7
  v_lshlrev_b32 v7, 1, v7
  v_xor_b32 v7, v5, v7
  v_lshlrev_b32 v7, 4, v7
  v_lshl_add_u32 v7, v6, 13, v7
  s_lshl_b32 s51, s32, 9
  v_add_u32 v11, s51, v7
  v_add_u32 v6, s50, v4
  v_add_u32 v6, 2, v6
  v_and_b32 v7, 3, v6
  v_bfe_u32 v8, v6, 3, 1
  v_lshl_or_b32 v7, v8, 2, v7
  v_lshlrev_b32 v7, 1, v7
  v_xor_b32 v7, v5, v7
  v_lshlrev_b32 v7, 4, v7
  v_lshl_add_u32 v7, v6, 13, v7
  s_lshl_b32 s51, s32, 9
  v_add_u32 v12, s51, v7
  s_lshl_b32 s50, s34, 11
  s_lshr_b32 s69, s2, 3
  s_mul_i32 s69, s69, 114688
  s_lshl_b32 s47, s34, 10
  s_add_u32 s69, s69, s47
  v_lshlrev_b32 v141, 4, v0
  s_mov_b32 s52, 0
  s_add_u32 s53, s50, 49152
  s_mov_b32 m0, s53
  s_mov_b32 s54, 0
  buffer_load_dwordx4 v11, s[12:15], s52 offen lds
  s_add_u32 s53, s50, 50176
  s_mov_b32 m0, s53
  s_nop 0
  buffer_load_dwordx4 v12, s[12:15], s52 offen lds
  s_add_u32 s53, s48, 65536
  s_mov_b32 m0, s53
  s_nop 0
  buffer_load_dwordx4 v10, s[8:11], s54 offen lds
  buffer_load_dwordx4 v[144:147], v141, s[60:63], s69 offen
  s_add_u32 s69, s69, 8192
  s_mov_b32 s52, 262144
  s_add_u32 s53, s50, 71680
  s_mov_b32 m0, s53
  s_mov_b32 s54, 64
  buffer_load_dwordx4 v11, s[12:15], s52 offen lds
  s_add_u32 s53, s50, 72704
  s_mov_b32 m0, s53
  s_nop 0
  buffer_load_dwordx4 v12, s[12:15], s52 offen lds
  s_add_u32 s53, s48, 88064
  s_mov_b32 m0, s53
  s_nop 0
  buffer_load_dwordx4 v10, s[8:11], s54 offen lds
  buffer_load_dwordx4 v[144:147], v141, s[60:63], s69 offen
  s_add_u32 s69, s69, 8192
  s_mov_b32 s52, 524288
  s_add_u32 s53, s50, 94208
  s_mov_b32 m0, s53
  s_mov_b32 s54, 128
  buffer_load_dwordx4 v11, s[12:15], s52 offen lds
  s_add_u32 s53, s50, 95232
  s_mov_b32 m0, s53
  s_nop 0
  buffer_load_dwordx4 v12, s[12:15], s52 offen lds
  s_add_u32 s53, s48, 110592
  s_mov_b32 m0, s53
  s_nop 0
  buffer_load_dwordx4 v10, s[8:11], s54 offen lds
  buffer_load_dwordx4 v[144:147], v141, s[60:63], s69 offen
  s_add_u32 s69, s69, 8192
  s_and_b32 s55, s34, 1
  s_lshr_b32 s56, s34, 1
  v_bfe_u32 v4, v2, 1, 2
  v_xor_b32 v4, v3, v4
  v_lshlrev_b32 v4, 4, v4
  v_lshl_add_u32 v4, v2, 6, v4
  s_mul_i32 s47, s55, 3072
  s_add_u32 s53, s47, 65536
  v_add_u32 v56, s53, v4
  v_lshrrev_b32 v4, 2, v2
  v_lshl_add_u32 v4, v3, 3, v4
  v_and_b32 v5, 3, v4
  v_bfe_u32 v6, v4, 3, 1
  v_lshl_or_b32 v5, v6, 2, v5
  v_lshlrev_b32 v5, 1, v5
  v_bfe_u32 v6, v2, 1, 1
  s_lshl_b32 s47, s56, 3
  v_add_u32 v6, s47, v6
  v_xor_b32 v5, v5, v6
  v_lshlrev_b32 v5, 4, v5
  v_lshl_add_u32 v5, v4, 9, v5
  v_and_b32 v6, 1, v2
  v_lshl_add_u32 v5, v6, 3, v5
  v_xor_b32 v6, 0, v5
  v_add_u32 v16, 49152, v6
  v_xor_b32 v6, 32, v5
  v_add_u32 v17, 49152, v6
  v_xor_b32 v6, 64, v5
  v_add_u32 v18, 49152, v6
  v_xor_b32 v6, 96, v5
  v_add_u32 v19, 49152, v6
  v_add_u32 v4, 4, v4
  v_and_b32 v5, 3, v4
  v_bfe_u32 v6, v4, 3, 1
  v_lshl_or_b32 v5, v6, 2, v5
  v_lshlrev_b32 v5, 1, v5
  v_bfe_u32 v6, v2, 1, 1
  s_lshl_b32 s47, s56, 3
  v_add_u32 v6, s47, v6
  v_xor_b32 v5, v5, v6
  v_lshlrev_b32 v5, 4, v5
  v_lshl_add_u32 v5, v4, 9, v5
  v_and_b32 v6, 1, v2
  v_lshl_add_u32 v5, v6, 3, v5
  v_xor_b32 v6, 0, v5
  v_add_u32 v20, 49152, v6
  v_xor_b32 v6, 32, v5
  v_add_u32 v21, 49152, v6
  v_xor_b32 v6, 64, v5
  v_add_u32 v22, 49152, v6
  v_xor_b32 v6, 96, v5
  v_add_u32 v23, 49152, v6
  v_mov_b32 v64, 0
  v_mov_b32 v65, 0
  v_mov_b32 v66, 0
  v_mov_b32 v67, 0
  v_mov_b32 v68, 0
  v_mov_b32 v69, 0
  v_mov_b32 v70, 0
  v_mov_b32 v71, 0
  v_mov_b32 v72, 0
  v_mov_b32 v73, 0
  v_mov_b32 v74, 0
  v_mov_b32 v75, 0
  v_mov_b32 v76, 0
  v_mov_b32 v77, 0
  v_mov_b32 v78, 0
  v_mov_b32 v79, 0
  v_mov_b32 v80, 0
  v_mov_b32 v81, 0
  v_mov_b32 v82, 0
  v_mov_b32 v83, 0
  v_mov_b32 v84, 0
  v_mov_b32 v85, 0
  v_mov_b32 v86, 0
  v_mov_b32 v87, 0
  v_mov_b32 v88, 0
  v_mov_b32 v89, 0
  v_mov_b32 v90, 0
  v_mov_b32 v91, 0
  v_mov_b32 v92, 0
  v_mov_b32 v93, 0
  v_mov_b32 v94, 0
  v_mov_b32 v95, 0
  v_mov_b32 v96, 0
  v_mov_b32 v97, 0
  v_mov_b32 v98, 0
  v_mov_b32 v99, 0
  v_mov_b32 v100, 0
  v_mov_b32 v101, 0
  v_mov_b32 v102, 0
  v_mov_b32 v103, 0
  v_mov_b32 v104, 0
  v_mov_b32 v105, 0
  v_mov_b32 v106, 0
  v_mov_b32 v107, 0
  v_mov_b32 v108, 0
  v_mov_b32 v109, 0
  v_mov_b32 v110, 0
  v_mov_b32 v111, 0
  s_mov_b32 s66, 0
  s_mov_b32 s67, 0
  s_mov_b32 s68, 67584
  s_mov_b32 s52, 786432
  s_mov_b32 s54, 192
K1_LOOP:
  s_waitcnt vmcnt(9)
  s_barrier
  s_add_u32 s53, s50, s68
  s_add_u32 s53, s53, 49152
  s_mov_b32 m0, s53
  v_add_u32 v57, s67, v56
  buffer_load_dwordx4 v11, s[12:15], s52 offen lds
  s_add_u32 s53, s53, 1024
  s_mov_b32 m0, s53
  s_add_u32 s53, s48, s68
  buffer_load_dwordx4 v12, s[12:15], s52 offen lds
  s_add_u32 s53, s53, 65536
  s_mov_b32 m0, s53
  v_add_u32 v24, s67, v16
  v_add_u32 v25, s67, v17
  v_add_u32 v26, s67, v18
  v_add_u32 v27, s67, v19
  v_add_u32 v28, s67, v20
  v_add_u32 v29, s67, v21
  v_add_u32 v30, s67, v22
  v_add_u32 v31, s67, v23
  buffer_load_dwordx4 v10, s[8:11], s54 offen lds
  buffer_load_dwordx4 v[144:147], v141, s[60:63], s69 offen
  s_add_u32 s69, s69, 8192
  ds_read_b128 v[112:115], v57 offset:0
  ds_read_b128 v[116:119], v57 offset:1024
  ds_read_b128 v[120:123], v57 offset:2048
  ds_read_b64_tr_b16 v[124:125], v24
  ds_read_b64_tr_b16 v[126:127], v28
  ds_read_b64_tr_b16 v[128:129], v25
  ds_read_b64_tr_b16 v[130:131], v29
  ds_read_b64_tr_b16 v[132:133], v26
  ds_read_b64_tr_b16 v[134:135], v30
  ds_read_b64_tr_b16 v[136:137], v27
  ds_read_b64_tr_b16 v[138:139], v31
  s_cmp_lg_u32 s66, 7
  s_cbranch_scc1 K1_NOPF
  v_lshlrev_b32 v5, 4, v140
  s_add_u32 s47, s46, 0
  buffer_load_dwordx4 v[144:147], v5, s[20:23], s47 offen
  s_add_u32 s47, s46, 8192
  buffer_load_dwordx4 v[144:147], v5, s[20:23], s47 offen
  s_add_u32 s47, s46, 16384
  buffer_load_dwordx4 v[144:147], v5, s[20:23], s47 offen
  s_add_u32 s47, s46, 196608
  buffer_load_dwordx4 v[144:147], v5, s[20:23], s47 offen
  s_add_u32 s47, s46, 204800
  buffer_load_dwordx4 v[144:147], v5, s[20:23], s47 offen
  s_add_u32 s47, s46, 212992
  buffer_load_dwordx4 v[144:147], v5, s[20:23], s47 offen
K1_NOPF:
  s_add_u32 s52, s52, 262144
  s_add_u32 s54, s54, 64
  s_add_u32 s67, s67, 22528
  s_cmp_eq_u32 s67, 90112
  s_cselect_b32 s67, 0, s67
  s_add_u32 s68, s68, 22528
  s_cmp_eq_u32 s68, 90112
  s_cselect_b32 s68, 0, s68
  s_waitcnt lgkmcnt(6)
  v_mfma_f32_16x16x32_bf16 v[64:67], v[124:127], v[112:115], v[64:67]
  v_mfma_f32_16x16x32_bf16 v[68:71], v[124:127], v[116:119], v[68:71]
  v_mfma_f32_16x16x32_bf16 v[72:75], v[124:127], v[120:123], v[72:75]
  s_waitcnt lgkmcnt(4)
  v_mfma_f32_16x16x32_bf16 v[76:79], v[128:131], v[112:115], v[76:79]
  v_mfma_f32_16x16x32_bf16 v[80:83], v[128:131], v[116:119], v[80:83]
  v_mfma_f32_16x16x32_bf16 v[84:87], v[128:131], v[120:123], v[84:87]
  s_waitcnt lgkmcnt(2)
  v_mfma_f32_16x16x32_bf16 v[88:91], v[132:135], v[112:115], v[88:91]
  v_mfma_f32_16x16x32_bf16 v[92:95], v[132:135], v[116:119], v[92:95]
  v_mfma_f32_16x16x32_bf16 v[96:99], v[132:135], v[120:123], v[96:99]
  s_waitcnt lgkmcnt(0)
  v_mfma_f32_16x16x32_bf16 v[100:103], v[136:139], v[112:115], v[100:103]
  v_mfma_f32_16x16x32_bf16 v[104:107], v[136:139], v[116:119], v[104:107]
  v_mfma_f32_16x16x32_bf16 v[108:111], v[136:139], v[120:123], v[108:111]
  s_add_u32 s66, s66, 1
  s_cmp_lt_u32 s66, 14
  s_cbranch_scc1 K1_LOOP
  s_waitcnt vmcnt(0)
  s_barrier
  v_lshrrev_b32 v4, 5, v0
  v_and_b32 v5, 31, v0
  v_add_u32 v6, s35, v4
  v_cmp_le_u32 vcc, 48, v6
  v_subrev_u32 v7, 48, v6
  s_nop 0
  v_cndmask_b32 v7, v6, v7, vcc
  v_mov_b32 v8, 0
  v_mov_b32 v9, 196608
  v_cndmask_b32 v8, v8, v9, vcc
  v_and_b32 v9, 7, v7
  v_lshlrev_b32 v9, 1, v9
  v_xor_b32 v9, v5, v9
  v_lshlrev_b32 v9, 4, v9
  v_lshl_add_u32 v9, v7, 9, v9
  v_add_u32 v9, v9, v8
  s_mul_i32 s47, s34, 6144
  s_add_u32 s47, s47, 49152
  s_mov_b32 m0, s47
  s_nop 0
  buffer_load_dwordx4 v9, s[20:23], s46 offen lds
  v_add_u32 v6, s35, v4
  v_add_u32 v6, 2, v6
  v_cmp_le_u32 vcc, 48, v6
  v_subrev_u32 v7, 48, v6
  s_nop 0
  v_cndmask_b32 v7, v6, v7, vcc
  v_mov_b32 v8, 0
  v_mov_b32 v9, 196608
  v_cndmask_b32 v8, v8, v9, vcc
  v_and_b32 v9, 7, v7
  v_lshlrev_b32 v9, 1, v9
  v_xor_b32 v9, v5, v9
  v_lshlrev_b32 v9, 4, v9
  v_lshl_add_u32 v9, v7, 9, v9
  v_add_u32 v9, v9, v8
  s_mul_i32 s47, s34, 6144
  s_add_u32 s47, s47, 50176
  s_mov_b32 m0, s47
  s_nop 0
  buffer_load_dwordx4 v9, s[20:23], s46 offen lds
  v_add_u32 v6, s35, v4
  v_add_u32 v6, 4, v6
  v_cmp_le_u32 vcc, 48, v6
  v_subrev_u32 v7, 48, v6
  s_nop 0
  v_cndmask_b32 v7, v6, v7, vcc
  v_mov_b32 v8, 0
  v_mov_b32 v9, 196608
  v_cndmask_b32 v8, v8, v9, vcc
  v_and_b32 v9, 7, v7
  v_lshlrev_b32 v9, 1, v9
  v_xor_b32 v9, v5, v9
  v_lshlrev_b32 v9, 4, v9
  v_lshl_add_u32 v9, v7, 9, v9
  v_add_u32 v9, v9, v8
  s_mul_i32 s47, s34, 6144
  s_add_u32 s47, s47, 51200
  s_mov_b32 m0, s47
  s_nop 0
  buffer_load_dwordx4 v9, s[20:23], s46 offen lds
  v_add_u32 v6, s35, v4
  v_add_u32 v6, 6, v6
  v_cmp_le_u32 vcc, 48, v6
  v_subrev_u32 v7, 48, v6
  s_nop 0
  v_cndmask_b32 v7, v6, v7, vcc
  v_mov_b32 v8, 0
  v_mov_b32 v9, 196608
  v_cndmask_b32 v8, v8, v9, vcc
  v_and_b32 v9, 7, v7
  v_lshlrev_b32 v9, 1, v9
  v_xor_b32 v9, v5, v9
  v_lshlrev_b32 v9, 4, v9
  v_lshl_add_u32 v9, v7, 9, v9
  v_add_u32 v9, v9, v8
  s_mul_i32 s47, s34, 6144
  s_add_u32 s47, s47, 52224
  s_mov_b32 m0, s47
  s_nop 0
  buffer_load_dwordx4 v9, s[20:23], s46 offen lds
  v_add_u32 v6, s35, v4
  v_add_u32 v6, 8, v6
  v_cmp_le_u32 vcc, 48, v6
  v_subrev_u32 v7, 48, v6
  s_nop 0
  v_cndmask_b32 v7, v6, v7, vcc
  v_mov_b32 v8, 0
  v_mov_b32 v9, 196608
  v_cndmask_b32 v8, v8, v9, vcc
  v_and_b32 v9, 7, v7
  v_lshlrev_b32 v9, 1, v9
  v_xor_b32 v9, v5, v9
  v_lshlrev_b32 v9, 4, v9
  v_lshl_add_u32 v9, v7, 9, v9
  v_add_u32 v9, v9, v8
  s_mul_i32 s47, s34, 6144
  s_add_u32 s47, s47, 53248
  s_mov_b32 m0, s47
  s_nop 0
  buffer_load_dwordx4 v9, s[20:23], s46 offen lds
  v_add_u32 v6, s35, v4
  v_add_u32 v6, 10, v6
  v_cmp_le_u32 vcc, 48, v6
  v_subrev_u32 v7, 48, v6
  s_nop 0
  v_cndmask_b32 v7, v6, v7, vcc
  v_mov_b32 v8, 0
  v_mov_b32 v9, 196608
  v_cndmask_b32 v8, v8, v9, vcc
  v_and_b32 v9, 7, v7
  v_lshlrev_b32 v9, 1, v9
  v_xor_b32 v9, v5, v9
  v_lshlrev_b32 v9, 4, v9
  v_lshl_add_u32 v9, v7, 9, v9
  v_add_u32 v9, v9, v8
  s_mul_i32 s47, s34, 6144
  s_add_u32 s47, s47, 54272
  s_mov_b32 m0, s47
  s_nop 0
  buffer_load_dwordx4 v9, s[20:23], s46 offen lds
  v_lshrrev_b32 v4, 1, v3
  s_lshl_b32 s47, s56, 3
  v_add_u32 v4, s47, v4
  v_xor_b32 v4, v4, v2
  v_lshlrev_b32 v4, 4, v4
  v_lshl_add_u32 v4, v2, 9, v4
  v_and_b32 v5, 1, v3
  v_lshl_add_u32 v4, v5, 3, v4
  s_mul_i32 s47, s55, 24576
  s_add_u32 s47, s47, 114688
  v_add_u32 v4, s47, v4
  v_xor_b32 v5, 0, v4
  v_cvt_pk_bf16_f32 v6, v64, v65
  v_cvt_pk_bf16_f32 v7, v66, v67
  ds_write_b64 v5, v[6:7] offset:0
  v_cvt_pk_bf16_f32 v6, v68, v69
  v_cvt_pk_bf16_f32 v7, v70, v71
  ds_write_b64 v5, v[6:7] offset:8192
  v_cvt_pk_bf16_f32 v6, v72, v73
  v_cvt_pk_bf16_f32 v7, v74, v75
  ds_write_b64 v5, v[6:7] offset:16384
  v_xor_b32 v5, 32, v4
  v_cvt_pk_bf16_f32 v6, v76, v77
  v_cvt_pk_bf16_f32 v7, v78, v79
  ds_write_b64 v5, v[6:7] offset:0
  v_cvt_pk_bf16_f32 v6, v80, v81
  v_cvt_pk_bf16_f32 v7, v82, v83
  ds_write_b64 v5, v[6:7] offset:8192
  v_cvt_pk_bf16_f32 v6, v84, v85
  v_cvt_pk_bf16_f32 v7, v86, v87
  ds_write_b64 v5, v[6:7] offset:16384
  v_xor_b32 v5, 64, v4
  v_cvt_pk_bf16_f32 v6, v88, v89
  v_cvt_pk_bf16_f32 v7, v90, v91
  ds_write_b64 v5, v[6:7] offset:0
  v_cvt_pk_bf16_f32 v6, v92, v93
  v_cvt_pk_bf16_f32 v7, v94, v95
  ds_write_b64 v5, v[6:7] offset:8192
  v_cvt_pk_bf16_f32 v6, v96, v97
  v_cvt_pk_bf16_f32 v7, v98, v99
  ds_write_b64 v5, v[6:7] offset:16384
  v_xor_b32 v5, 96, v4
  v_cvt_pk_bf16_f32 v6, v100, v101
  v_cvt_pk_bf16_f32 v7, v102, v103
  ds_write_b64 v5, v[6:7] offset:0
  v_cvt_pk_bf16_f32 v6, v104, v105
  v_cvt_pk_bf16_f32 v7, v106, v107
  ds_write_b64 v5, v[6:7] offset:8192
  v_cvt_pk_bf16_f32 v6, v108, v109
  v_cvt_pk_bf16_f32 v7, v110, v111
  ds_write_b64 v5, v[6:7] offset:16384
  s_waitcnt lgkmcnt(0)
  s_barrier
  s_cmp_ge_u32 s34, 6
  s_cbranch_scc1 K1_WOPF
  s_cmp_ge_u32 s34, 3
  s_cselect_b32 s55, 1, 0
  s_mul_i32 s47, s55, 3
  s_sub_u32 s56, s34, s47
  v_xor_b32 v4, v3, v2
  v_lshlrev_b32 v4, 4, v4
  v_lshl_add_u32 v4, v2, 9, v4
  s_mul_i32 s47, s55, 24576
  s_add_u32 s53, s47, 0
  v_add_u32 v5, s53, v4
  s_lshl_b32 s53, s56, 13
  s_add_u32 s53, s53, s47
  s_add_u32 s53, s53, 114688
  v_add_u32 v6, s53, v4
  v_mov_b32 v64, 0
  v_mov_b32 v65, 0
  v_mov_b32 v66, 0
  v_mov_b32 v67, 0
  v_mov_b32 v68, 0
  v_mov_b32 v69, 0
  v_mov_b32 v70, 0
  v_mov_b32 v71, 0
  v_mov_b32 v72, 0
  v_mov_b32 v73, 0
  v_mov_b32 v74, 0
  v_mov_b32 v75, 0
  v_xor_b32 v8, 0, v6
  ds_read_b128 v[112:115], v8
  v_xor_b32 v8, 64, v6
  ds_read_b128 v[116:119], v8
  v_xor_b32 v8, 128, v6
  ds_read_b128 v[120:123], v8
  v_xor_b32 v8, 192, v6
  ds_read_b128 v[124:127], v8
  v_xor_b32 v8, 256, v6
  ds_read_b128 v[128:131], v8
  v_xor_b32 v8, 320, v6
  ds_read_b128 v[132:135], v8
  v_xor_b32 v8, 384, v6
  ds_read_b128 v[136:139], v8
  v_xor_b32 v8, 448, v6
  ds_read_b128 v[140:143], v8
  v_xor_b32 v7, 0, v5
  ds_read_b128 v[16:19], v7 offset:0
  ds_read_b128 v[20:23], v7 offset:8192
  ds_read_b128 v[24:27], v7 offset:16384
  v_xor_b32 v7, 64, v5
  ds_read_b128 v[28:31], v7 offset:0
  ds_read_b128 v[32:35], v7 offset:8192
  ds_read_b128 v[36:39], v7 offset:16384
  v_xor_b32 v7, 128, v5
  ds_read_b128 v[40:43], v7 offset:0
  ds_read_b128 v[44:47], v7 offset:8192
  ds_read_b128 v[48:51], v7 offset:16384
  v_xor_b32 v7, 192, v5
  ds_read_b128 v[52:55], v7 offset:0
  ds_read_b128 v[56:59], v7 offset:8192
  ds_read_b128 v[60:63], v7 offset:16384
  s_waitcnt lgkmcnt(9)
  v_mfma_f32_16x16x32_bf16 v[64:67], v[16:19], v[112:115], v[64:67]
  v_mfma_f32_16x16x32_bf16 v[68:71], v[20:23], v[112:115], v[68:71]
  v_mfma_f32_16x16x32_bf16 v[72:75], v[24:27], v[112:115], v[72:75]
  s_waitcnt lgkmcnt(6)
  v_mfma_f32_16x16x32_bf16 v[64:67], v[28:31], v[116:119], v[64:67]
  v_mfma_f32_16x16x32_bf16 v[68:71], v[32:35], v[116:119], v[68:71]
  v_mfma_f32_16x16x32_bf16 v[72:75], v[36:39], v[116:119], v[72:75]
  s_waitcnt lgkmcnt(3)
  v_mfma_f32_16x16x32_bf16 v[64:67], v[40:43], v[120:123], v[64:67]
  v_mfma_f32_16x16x32_bf16 v[68:71], v[44:47], v[120:123], v[68:71]
  v_mfma_f32_16x16x32_bf16 v[72:75], v[48:51], v[120:123], v[72:75]
  s_waitcnt lgkmcnt(0)
  v_mfma_f32_16x16x32_bf16 v[64:67], v[52:55], v[124:127], v[64:67]
  v_mfma_f32_16x16x32_bf16 v[68:71], v[56:59], v[124:127], v[68:71]
  v_mfma_f32_16x16x32_bf16 v[72:75], v[60:63], v[124:127], v[72:75]
  v_xor_b32 v7, 256, v5
  ds_read_b128 v[16:19], v7 offset:0
  ds_read_b128 v[20:23], v7 offset:8192
  ds_read_b128 v[24:27], v7 offset:16384
  v_xor_b32 v7, 320, v5
  ds_read_b128 v[28:31], v7 offset:0
  ds_read_b128 v[32:35], v7 offset:8192
  ds_read_b128 v[36:39], v7 offset:16384
  v_xor_b32 v7, 384, v5
  ds_read_b128 v[40:43], v7 offset:0
  ds_read_b128 v[44:47], v7 offset:8192
  ds_read_b128 v[48:51], v7 offset:16384
  v_xor_b32 v7, 448, v5
  ds_read_b128 v[52:55], v7 offset:0
  ds_read_b128 v[56:59], v7 offset:8192
  ds_read_b128 v[60:63], v7 offset:16384
  s_waitcnt lgkmcnt(9)
  v_mfma_f32_16x16x32_bf16 v[64:67], v[16:19], v[128:131], v[64:67]
  v_mfma_f32_16x16x32_bf16 v[68:71], v[20:23], v[128:131], v[68:71]
  v_mfma_f32_16x16x32_bf16 v[72:75], v[24:27], v[128:131], v[72:75]
  s_waitcnt lgkmcnt(6)
  v_mfma_f32_16x16x32_bf16 v[64:67], v[28:31], v[132:135], v[64:67]
  v_mfma_f32_16x16x32_bf16 v[68:71], v[32:35], v[132:135], v[68:71]
  v_mfma_f32_16x16x32_bf16 v[72:75], v[36:39], v[132:135], v[72:75]
  s_waitcnt lgkmcnt(3)
  v_mfma_f32_16x16x32_bf16 v[64:67], v[40:43], v[136:139], v[64:67]
  v_mfma_f32_16x16x32_bf16 v[68:71], v[44:47], v[136:139], v[68:71]
  v_mfma_f32_16x16x32_bf16 v[72:75], v[48:51], v[136:139], v[72:75]
  s_waitcnt lgkmcnt(0)
  v_mfma_f32_16x16x32_bf16 v[64:67], v[52:55], v[140:143], v[64:67]
  v_mfma_f32_16x16x32_bf16 v[68:71], v[56:59], v[140:143], v[68:71]
  v_mfma_f32_16x16x32_bf16 v[72:75], v[60:63], v[140:143], v[72:75]
  s_nop 7
  s_nop 1
  v_max_f32 v9, v64, v65
  v_max_f32 v9, v9, v66
  v_max_f32 v9, v9, v67
  v_max_f32 v9, v9, v68
  v_max_f32 v9, v9, v69
  v_max_f32 v9, v9, v70
  v_max_f32 v9, v9, v71
  v_max_f32 v9, v9, v72
  v_max_f32 v9, v9, v73
  v_max_f32 v9, v9, v74
  v_max_f32 v9, v9, v75
  v_mov_b32 v10, v9
  s_nop 1
  v_permlane16_swap_b32 v9, v10
  v_max_f32 v9, v9, v10
  v_mov_b32 v10, v9
  s_nop 1
  v_permlane32_swap_b32 v9, v10
  v_max_f32 v9, v9, v10
  s_mov_b32 s47, 0x3db8aa3b
  v_mul_f32 v9, s47, v9
  v_fma_f32 v64, v64, s47, -v9
  v_fma_f32 v65, v65, s47, -v9
  v_fma_f32 v66, v66, s47, -v9
  v_fma_f32 v67, v67, s47, -v9
  v_fma_f32 v68, v68, s47, -v9
  v_fma_f32 v69, v69, s47, -v9
  v_fma_f32 v70, v70, s47, -v9
  v_fma_f32 v71, v71, s47, -v9
  v_fma_f32 v72, v72, s47, -v9
  v_fma_f32 v73, v73, s47, -v9
  v_fma_f32 v74, v74, s47, -v9
  v_fma_f32 v75, v75, s47, -v9
  v_exp_f32 v64, v64
  v_exp_f32 v65, v65
  v_exp_f32 v66, v66
  v_exp_f32 v67, v67
  v_exp_f32 v68, v68
  v_exp_f32 v69, v69
  v_exp_f32 v70, v70
  v_exp_f32 v71, v71
  v_exp_f32 v72, v72
  v_exp_f32 v73, v73
  v_exp_f32 v74, v74
  v_exp_f32 v75, v75
  s_nop 0
  v_add_f32 v10, v64, v65
  v_add_f32 v10, v10, v66
  v_add_f32 v10, v10, v67
  v_add_f32 v10, v10, v68
  v_add_f32 v10, v10, v69
  v_add_f32 v10, v10, v70
  v_add_f32 v10, v10, v71
  v_add_f32 v10, v10, v72
  v_add_f32 v10, v10, v73
  v_add_f32 v10, v10, v74
  v_add_f32 v10, v10, v75
  v_mov_b32 v11, v10
  s_nop 1
  v_permlane16_swap_b32 v10, v11
  v_add_f32 v10, v10, v11
  v_mov_b32 v11, v10
  s_nop 1
  v_permlane32_swap_b32 v10, v11
  v_add_f32 v10, v10, v11
  v_rcp_f32 v10, v10
  s_nop 0
  v_mul_f32 v64, v64, v10
  v_mul_f32 v65, v65, v10
  v_mul_f32 v66, v66, v10
  v_mul_f32 v67, v67, v10
  v_mul_f32 v68, v68, v10
  v_mul_f32 v69, v69, v10
  v_mul_f32 v70, v70, v10
  v_mul_f32 v71, v71, v10
  v_mul_f32 v72, v72, v10
  v_mul_f32 v73, v73, v10
  v_mul_f32 v74, v74, v10
  v_mul_f32 v75, v75, v10
  v_cvt_pk_bf16_f32 v76, v64, v65
  v_cvt_pk_bf16_f32 v77, v66, v67
  v_cvt_pk_bf16_f32 v78, v68, v69
  v_cvt_pk_bf16_f32 v79, v70, v71
  v_cvt_pk_bf16_f32 v80, v72, v73
  v_cvt_pk_bf16_f32 v81, v74, v75
  v_lshrrev_b32 v4, 2, v2
  v_lshl_add_u32 v4, v3, 2, v4
  v_and_b32 v5, 7, v4
  v_lshlrev_b32 v5, 1, v5
  v_bfe_u32 v6, v2, 1, 1
  v_xor_b32 v5, v5, v6
  v_lshlrev_b32 v5, 4, v5
  v_lshl_add_u32 v5, v4, 9, v5
  v_and_b32 v6, 1, v2
  v_lshl_add_u32 v5, v6, 3, v5
  s_mul_i32 s47, s55, 24576
  s_add_u32 s47, s47, 49152
  v_add_u32 v5, s47, v5
  s_mul_i32 s47, s31, 48
  s_mul_i32 s53, s30, 6
  s_add_u32 s47, s47, s53
  s_add_u32 s47, s47, s34
  s_lshl_b32 s47, s47, 7
  s_lshl_b32 s53, s32, 3
  s_add_u32 s47, s47, s53
  s_lshl_b32 s47, s47, 10
  v_lshlrev_b32 v7, 4, v0
  s_waitcnt vmcnt(0)
  s_barrier
  v_xor_b32 v6, 0, v5
  ds_read_b64_tr_b16 v[16:17], v6
  ds_read_b64_tr_b16 v[18:19], v6 offset:8192
  ds_read_b64_tr_b16 v[20:21], v6 offset:16384
  v_xor_b32 v6, 32, v5
  ds_read_b64_tr_b16 v[22:23], v6
  ds_read_b64_tr_b16 v[24:25], v6 offset:8192
  ds_read_b64_tr_b16 v[26:27], v6 offset:16384
  v_xor_b32 v6, 64, v5
  ds_read_b64_tr_b16 v[28:29], v6
  ds_read_b64_tr_b16 v[30:31], v6 offset:8192
  ds_read_b64_tr_b16 v[32:33], v6 offset:16384
  v_xor_b32 v6, 96, v5
  ds_read_b64_tr_b16 v[34:35], v6
  ds_read_b64_tr_b16 v[36:37], v6 offset:8192
  ds_read_b64_tr_b16 v[38:39], v6 offset:16384
  v_xor_b32 v6, 128, v5
  ds_read_b64_tr_b16 v[40:41], v6
  ds_read_b64_tr_b16 v[42:43], v6 offset:8192
  ds_read_b64_tr_b16 v[44:45], v6 offset:16384
  v_xor_b32 v6, 160, v5
  ds_read_b64_tr_b16 v[46:47], v6
  ds_read_b64_tr_b16 v[48:49], v6 offset:8192
  ds_read_b64_tr_b16 v[50:51], v6 offset:16384
  v_xor_b32 v6, 192, v5
  ds_read_b64_tr_b16 v[52:53], v6
  ds_read_b64_tr_b16 v[54:55], v6 offset:8192
  ds_read_b64_tr_b16 v[56:57], v6 offset:16384
  v_xor_b32 v6, 224, v5
  ds_read_b64_tr_b16 v[58:59], v6
  ds_read_b64_tr_b16 v[60:61], v6 offset:8192
  ds_read_b64_tr_b16 v[62:63], v6 offset:16384
  s_waitcnt lgkmcnt(12)
  v_mfma_f32_16x16x32_bf16 v[112:115], v[16:19], v[76:79], 0
  v_mfma_f32_16x16x32_bf16 v[116:119], v[22:25], v[76:79], 0
  v_mfma_f32_16x16x32_bf16 v[120:123], v[28:31], v[76:79], 0
  v_mfma_f32_16x16x32_bf16 v[124:127], v[34:37], v[76:79], 0
  s_nop 1
  v_mfma_f32_16x16x16_bf16 v[112:115], v[20:21], v[80:81], v[112:115]
  v_mfma_f32_16x16x16_bf16 v[116:119], v[26:27], v[80:81], v[116:119]
  v_mfma_f32_16x16x16_bf16 v[120:123], v[32:33], v[80:81], v[120:123]
  v_mfma_f32_16x16x16_bf16 v[124:127], v[38:39], v[80:81], v[124:127]
  s_nop 7
  v_cvt_pk_bf16_f32 v84, v112, v113
  v_cvt_pk_bf16_f32 v85, v114, v115
  v_cvt_pk_bf16_f32 v86, v116, v117
  v_cvt_pk_bf16_f32 v87, v118, v119
  buffer_store_dwordx4 v[84:87], v7, s[24:27], s47 offen
  s_add_u32 s47, s47, 1024
  v_cvt_pk_bf16_f32 v88, v120, v121
  v_cvt_pk_bf16_f32 v89, v122, v123
  v_cvt_pk_bf16_f32 v90, v124, v125
  v_cvt_pk_bf16_f32 v91, v126, v127
  buffer_store_dwordx4 v[88:91], v7, s[24:27], s47 offen
  s_add_u32 s47, s47, 1024
  v_xor_b32 v6, 256, v5
  ds_read_b64_tr_b16 v[16:17], v6
  ds_read_b64_tr_b16 v[18:19], v6 offset:8192
  ds_read_b64_tr_b16 v[20:21], v6 offset:16384
  v_xor_b32 v6, 288, v5
  ds_read_b64_tr_b16 v[22:23], v6
  ds_read_b64_tr_b16 v[24:25], v6 offset:8192
  ds_read_b64_tr_b16 v[26:27], v6 offset:16384
  v_xor_b32 v6, 320, v5
  ds_read_b64_tr_b16 v[28:29], v6
  ds_read_b64_tr_b16 v[30:31], v6 offset:8192
  ds_read_b64_tr_b16 v[32:33], v6 offset:16384
  v_xor_b32 v6, 352, v5
  ds_read_b64_tr_b16 v[34:35], v6
  ds_read_b64_tr_b16 v[36:37], v6 offset:8192
  ds_read_b64_tr_b16 v[38:39], v6 offset:16384
  s_waitcnt lgkmcnt(12)
  v_mfma_f32_16x16x32_bf16 v[128:131], v[40:43], v[76:79], 0
  v_mfma_f32_16x16x32_bf16 v[132:135], v[46:49], v[76:79], 0
  v_mfma_f32_16x16x32_bf16 v[136:139], v[52:55], v[76:79], 0
  v_mfma_f32_16x16x32_bf16 v[140:143], v[58:61], v[76:79], 0
  s_nop 1
  v_mfma_f32_16x16x16_bf16 v[128:131], v[44:45], v[80:81], v[128:131]
  v_mfma_f32_16x16x16_bf16 v[132:135], v[50:51], v[80:81], v[132:135]
  v_mfma_f32_16x16x16_bf16 v[136:139], v[56:57], v[80:81], v[136:139]
  v_mfma_f32_16x16x16_bf16 v[140:143], v[62:63], v[80:81], v[140:143]
  s_nop 7
  v_cvt_pk_bf16_f32 v92, v128, v129
  v_cvt_pk_bf16_f32 v93, v130, v131
  v_cvt_pk_bf16_f32 v94, v132, v133
  v_cvt_pk_bf16_f32 v95, v134, v135
  buffer_store_dwordx4 v[92:95], v7, s[24:27], s47 offen
  s_add_u32 s47, s47, 1024
  v_cvt_pk_bf16_f32 v96, v136, v137
  v_cvt_pk_bf16_f32 v97, v138, v139
  v_cvt_pk_bf16_f32 v98, v140, v141
  v_cvt_pk_bf16_f32 v99, v142, v143
  buffer_store_dwordx4 v[96:99], v7, s[24:27], s47 offen
  s_add_u32 s47, s47, 1024
  v_xor_b32 v6, 384, v5
  ds_read_b64_tr_b16 v[40:41], v6
  ds_read_b64_tr_b16 v[42:43], v6 offset:8192
  ds_read_b64_tr_b16 v[44:45], v6 offset:16384
  v_xor_b32 v6, 416, v5
  ds_read_b64_tr_b16 v[46:47], v6
  ds_read_b64_tr_b16 v[48:49], v6 offset:8192
  ds_read_b64_tr_b16 v[50:51], v6 offset:16384
  v_xor_b32 v6, 448, v5
  ds_read_b64_tr_b16 v[52:53], v6
  ds_read_b64_tr_b16 v[54:55], v6 offset:8192
  ds_read_b64_tr_b16 v[56:57], v6 offset:16384
  v_xor_b32 v6, 480, v5
  ds_read_b64_tr_b16 v[58:59], v6
  ds_read_b64_tr_b16 v[60:61], v6 offset:8192
  ds_read_b64_tr_b16 v[62:63], v6 offset:16384
  s_waitcnt lgkmcnt(12)
  v_mfma_f32_16x16x32_bf16 v[112:115], v[16:19], v[76:79], 0
  v_mfma_f32_16x16x32_bf16 v[116:119], v[22:25], v[76:79], 0
  v_mfma_f32_16x16x32_bf16 v[120:123], v[28:31], v[76:79], 0
  v_mfma_f32_16x16x32_bf16 v[124:127], v[34:37], v[76:79], 0
  s_nop 1
  v_mfma_f32_16x16x16_bf16 v[112:115], v[20:21], v[80:81], v[112:115]
  v_mfma_f32_16x16x16_bf16 v[116:119], v[26:27], v[80:81], v[116:119]
  v_mfma_f32_16x16x16_bf16 v[120:123], v[32:33], v[80:81], v[120:123]
  v_mfma_f32_16x16x16_bf16 v[124:127], v[38:39], v[80:81], v[124:127]
  s_nop 7
  v_cvt_pk_bf16_f32 v84, v112, v113
  v_cvt_pk_bf16_f32 v85, v114, v115
  v_cvt_pk_bf16_f32 v86, v116, v117
  v_cvt_pk_bf16_f32 v87, v118, v119
  buffer_store_dwordx4 v[84:87], v7, s[24:27], s47 offen
  s_add_u32 s47, s47, 1024
  v_cvt_pk_bf16_f32 v88, v120, v121
  v_cvt_pk_bf16_f32 v89, v122, v123
  v_cvt_pk_bf16_f32 v90, v124, v125
  v_cvt_pk_bf16_f32 v91, v126, v127
  buffer_store_dwordx4 v[88:91], v7, s[24:27], s47 offen
  s_add_u32 s47, s47, 1024
  s_waitcnt lgkmcnt(0)
  v_mfma_f32_16x16x32_bf16 v[128:131], v[40:43], v[76:79], 0
  v_mfma_f32_16x16x32_bf16 v[132:135], v[46:49], v[76:79], 0
  v_mfma_f32_16x16x32_bf16 v[136:139], v[52:55], v[76:79], 0
  v_mfma_f32_16x16x32_bf16 v[140:143], v[58:61], v[76:79], 0
  s_nop 1
  v_mfma_f32_16x16x16_bf16 v[128:131], v[44:45], v[80:81], v[128:131]
  v_mfma_f32_16x16x16_bf16 v[132:135], v[50:51], v[80:81], v[132:135]
  v_mfma_f32_16x16x16_bf16 v[136:139], v[56:57], v[80:81], v[136:139]
  v_mfma_f32_16x16x16_bf16 v[140:143], v[62:63], v[80:81], v[140:143]
  s_nop 7
  v_cvt_pk_bf16_f32 v92, v128, v129
  v_cvt_pk_bf16_f32 v93, v130, v131
  v_cvt_pk_bf16_f32 v94, v132, v133
  v_cvt_pk_bf16_f32 v95, v134, v135
  buffer_store_dwordx4 v[92:95], v7, s[24:27], s47 offen
  s_add_u32 s47, s47, 1024
  v_cvt_pk_bf16_f32 v96, v136, v137
  v_cvt_pk_bf16_f32 v97, v138, v139
  v_cvt_pk_bf16_f32 v98, v140, v141
  v_cvt_pk_bf16_f32 v99, v142, v143
  buffer_store_dwordx4 v[96:99], v7, s[24:27], s47 offen
  s_add_u32 s47, s47, 1024
  s_branch K1_END
K1_WOPF:
  s_waitcnt vmcnt(0)
  s_barrier
K1_END:
  s_waitcnt vmcnt(0)
  s_endpgm
.p2align 8
.globl oproj_kernel
.type oproj_kernel,@function
oproj_kernel:
  s_cmp_ge_u32 s2, 224
  s_cbranch_scc1 K2_END
  s_and_b32 s28, s2, 7
  s_lshr_b32 s29, s2, 3
  s_mov_b32 s30, 0
  s_cmp_ge_u32 s29, 7
  s_cselect_b32 s30, 1, s30
  s_cmp_ge_u32 s29, 14
  s_cselect_b32 s30, 2, s30
  s_cmp_ge_u32 s29, 21
  s_cselect_b32 s30, 3, s30
  s_mul_i32 s31, s30, 7
  s_sub_u32 s31, s29, s31
  s_lshr_b32 s32, s28, 2
  s_and_b32 s33, s28, 3
  s_lshl_b32 s33, s33, 2
  s_add_u32 s33, s33, s30
  s_mul_i32 s35, s32, 40
  s_load_dwordx2 s[36:37], s[0:1], s35 offset:32
  s_load_dwordx2 s[38:39], s[0:1], 80
  s_load_dwordx2 s[40:41], s[0:1], 96
  v_lshrrev_b32 v1, 6, v0
  v_and_b32 v0, 63, v0
  v_readfirstlane_b32 s34, v1
  s_waitcnt lgkmcnt(0)
  s_mov_b32 s8, s36
  s_mov_b32 s9, s37
  s_mov_b32 s10, 3670016
  s_mov_b32 s11, 0x00020000
  s_mov_b32 s12, s38
  s_mov_b32 s13, s39
  s_mov_b32 s14, 1376256
  s_mov_b32 s15, 0x00020000
  s_mov_b32 s16, s40
  s_mov_b32 s17, s41
  s_mov_b32 s18, 12582912
  s_mov_b32 s19, 0x00020000
  v_and_b32 v2, 15, v0
  v_lshrrev_b32 v3, 4, v0
  v_lshrrev_b32 v4, 3, v0
  v_and_b32 v5, 7, v0
  v_bfe_u32 v6, v4, 1, 2
  v_lshlrev_b32 v6, 1, v6
  v_xor_b32 v5, v5, v6
  v_mul_u32_u24 v4, 896, v4
  v_lshl_add_u32 v4, v5, 4, v4
  s_lshl_b32 s42, s31, 7
  v_add_u32 v10, s42, v4
  s_mul_i32 s43, s34, 458752
  s_lshl_b32 s44, s34, 14
  v_lshlrev_b32 v11, 4, v0
  s_mul_i32 s45, s32, 48
  s_mul_i32 s46, s33, 3
  s_add_u32 s45, s45, s46
  s_lshl_b32 s45, s45, 7
  s_lshl_b32 s46, s34, 4
  s_add_u32 s45, s45, s46
  s_lshl_b32 s45, s45, 10
  v_lshrrev_b32 v4, 2, v2
  v_lshl_add_u32 v4, v3, 2, v4
  v_bfe_u32 v5, v4, 1, 2
  v_lshlrev_b32 v5, 1, v5
  v_bfe_u32 v6, v2, 1, 1
  v_xor_b32 v5, v5, v6
  v_lshlrev_b32 v5, 4, v5
  v_lshl_add_u32 v5, v4, 7, v5
  v_and_b32 v6, 1, v2
  v_lshl_add_u32 v5, v6, 3, v5
  v_add_u32 v5, s44, v5
  v_xor_b32 v12, 0, v5
  v_xor_b32 v13, 32, v5
  v_xor_b32 v14, 64, v5
  v_xor_b32 v15, 96, v5
  v_mov_b32 v64, 0
  v_mov_b32 v65, 0
  v_mov_b32 v66, 0
  v_mov_b32 v67, 0
  v_mov_b32 v68, 0
  v_mov_b32 v69, 0
  v_mov_b32 v70, 0
  v_mov_b32 v71, 0
  v_mov_b32 v72, 0
  v_mov_b32 v73, 0
  v_mov_b32 v74, 0
  v_mov_b32 v75, 0
  v_mov_b32 v76, 0
  v_mov_b32 v77, 0
  v_mov_b32 v78, 0
  v_mov_b32 v79, 0
  v_mov_b32 v80, 0
  v_mov_b32 v81, 0
  v_mov_b32 v82, 0
  v_mov_b32 v83, 0
  v_mov_b32 v84, 0
  v_mov_b32 v85, 0
  v_mov_b32 v86, 0
  v_mov_b32 v87, 0
  v_mov_b32 v88, 0
  v_mov_b32 v89, 0
  v_mov_b32 v90, 0
  v_mov_b32 v91, 0
  v_mov_b32 v92, 0
  v_mov_b32 v93, 0
  v_mov_b32 v94, 0
  v_mov_b32 v95, 0
  v_mov_b32 v96, 0
  v_mov_b32 v97, 0
  v_mov_b32 v98, 0
  v_mov_b32 v99, 0
  v_mov_b32 v100, 0
  v_mov_b32 v101, 0
  v_mov_b32 v102, 0
  v_mov_b32 v103, 0
  v_mov_b32 v104, 0
  v_mov_b32 v105, 0
  v_mov_b32 v106, 0
  v_mov_b32 v107, 0
  v_mov_b32 v108, 0
  v_mov_b32 v109, 0
  v_mov_b32 v110, 0
  v_mov_b32 v111, 0
  s_add_u32 s47, s43, 0
  s_add_u32 s48, s44, 0
  s_mov_b32 m0, s48
  s_add_u32 s49, s47, 0
  buffer_load_dwordx4 v10, s[8:11], s49 offen lds
  s_add_u32 s48, s44, 1024
  s_mov_b32 m0, s48
  s_add_u32 s49, s47, 7168
  buffer_load_dwordx4 v10, s[8:11], s49 offen lds
  s_add_u32 s48, s44, 2048
  s_mov_b32 m0, s48
  s_add_u32 s49, s47, 14336
  buffer_load_dwordx4 v10, s[8:11], s49 offen lds
  s_add_u32 s48, s44, 3072
  s_mov_b32 m0, s48
  s_add_u32 s49, s47, 21504
  buffer_load_dwordx4 v10, s[8:11], s49 offen lds
  s_add_u32 s47, s45, 0
  buffer_load_dwordx4 v[112:115], v11, s[16:19], s47 offen
  s_add_u32 s47, s47, 131072
  buffer_load_dwordx4 v[116:119], v11, s[16:19], s47 offen
  s_add_u32 s47, s47, 131072
  buffer_load_dwordx4 v[120:123], v11, s[16:19], s47 offen
  s_add_u32 s47, s43, 28672
  s_add_u32 s48, s44, 4096
  s_mov_b32 m0, s48
  s_add_u32 s49, s47, 0
  buffer_load_dwordx4 v10, s[8:11], s49 offen lds
  s_add_u32 s48, s44, 5120
  s_mov_b32 m0, s48
  s_add_u32 s49, s47, 7168
  buffer_load_dwordx4 v10, s[8:11], s49 offen lds
  s_add_u32 s48, s44, 6144
  s_mov_b32 m0, s48
  s_add_u32 s49, s47, 14336
  buffer_load_dwordx4 v10, s[8:11], s49 offen lds
  s_add_u32 s48, s44, 7168
  s_mov_b32 m0, s48
  s_add_u32 s49, s47, 21504
  buffer_load_dwordx4 v10, s[8:11], s49 offen lds
  s_add_u32 s47, s45, 1024
  buffer_load_dwordx4 v[124:127], v11, s[16:19], s47 offen
  s_add_u32 s47, s47, 131072
  buffer_load_dwordx4 v[128:131], v11, s[16:19], s47 offen
  s_add_u32 s47, s47, 131072
  buffer_load_dwordx4 v[132:135], v11, s[16:19], s47 offen
  s_add_u32 s47, s43, 57344
  s_add_u32 s48, s44, 8192
  s_mov_b32 m0, s48
  s_add_u32 s49, s47, 0
  buffer_load_dwordx4 v10, s[8:11], s49 offen lds
  s_add_u32 s48, s44, 9216
  s_mov_b32 m0, s48
  s_add_u32 s49, s47, 7168
  buffer_load_dwordx4 v10, s[8:11], s49 offen lds
  s_add_u32 s48, s44, 10240
  s_mov_b32 m0, s48
  s_add_u32 s49, s47, 14336
  buffer_load_dwordx4 v10, s[8:11], s49 offen lds
  s_add_u32 s48, s44, 11264
  s_mov_b32 m0, s48
  s_add_u32 s49, s47, 21504
  buffer_load_dwordx4 v10, s[8:11], s49 offen lds
  s_add_u32 s47, s45, 2048
  buffer_load_dwordx4 v[136:139], v11, s[16:19], s47 offen
  s_add_u32 s47, s47, 131072
  buffer_load_dwordx4 v[140:143], v11, s[16:19], s47 offen
  s_add_u32 s47, s47, 131072
  buffer_load_dwordx4 v[144:147], v11, s[16:19], s47 offen
  s_add_u32 s47, s43, 86016
  s_add_u32 s48, s44, 12288
  s_mov_b32 m0, s48
  s_add_u32 s49, s47, 0
  buffer_load_dwordx4 v10, s[8:11], s49 offen lds
  s_add_u32 s48, s44, 13312
  s_mov_b32 m0, s48
  s_add_u32 s49, s47, 7168
  buffer_load_dwordx4 v10, s[8:11], s49 offen lds
  s_add_u32 s48, s44, 14336
  s_mov_b32 m0, s48
  s_add_u32 s49, s47, 14336
  buffer_load_dwordx4 v10, s[8:11], s49 offen lds
  s_add_u32 s48, s44, 15360
  s_mov_b32 m0, s48
  s_add_u32 s49, s47, 21504
  buffer_load_dwordx4 v10, s[8:11], s49 offen lds
  s_add_u32 s47, s45, 3072
  buffer_load_dwordx4 v[148:151], v11, s[16:19], s47 offen
  s_add_u32 s47, s47, 131072
  buffer_load_dwordx4 v[152:155], v11, s[16:19], s47 offen
  s_add_u32 s47, s47, 131072
  buffer_load_dwordx4 v[156:159], v11, s[16:19], s47 offen
  s_waitcnt vmcnt(21)
  ds_read_b64_tr_b16 v[40:41], v12 offset:0
  ds_read_b64_tr_b16 v[42:43], v12 offset:2048
  ds_read_b64_tr_b16 v[44:45], v13 offset:0
  ds_read_b64_tr_b16 v[46:47], v13 offset:2048
  ds_read_b64_tr_b16 v[48:49], v14 offset:0
  ds_read_b64_tr_b16 v[50:51], v14 offset:2048
  ds_read_b64_tr_b16 v[52:53], v15 offset:0
  ds_read_b64_tr_b16 v[54:55], v15 offset:2048
  s_waitcnt lgkmcnt(6)
  v_mfma_f32_16x16x32_bf16 v[64:67], v[112:115], v[40:43], v[64:67]
  v_mfma_f32_16x16x32_bf16 v[80:83], v[116:119], v[40:43], v[80:83]
  v_mfma_f32_16x16x32_bf16 v[96:99], v[120:123], v[40:43], v[96:99]
  s_waitcnt lgkmcnt(4)
  v_mfma_f32_16x16x32_bf16 v[68:71], v[112:115], v[44:47], v[68:71]
  v_mfma_f32_16x16x32_bf16 v[84:87], v[116:119], v[44:47], v[84:87]
  v_mfma_f32_16x16x32_bf16 v[100:103], v[120:123], v[44:47], v[100:103]
  s_waitcnt lgkmcnt(2)
  v_mfma_f32_16x16x32_bf16 v[72:75], v[112:115], v[48:51], v[72:75]
  v_mfma_f32_16x16x32_bf16 v[88:91], v[116:119], v[48:51], v[88:91]
  v_mfma_f32_16x16x32_bf16 v[104:107], v[120:123], v[48:51], v[104:107]
  s_waitcnt lgkmcnt(0)
  v_mfma_f32_16x16x32_bf16 v[76:79], v[112:115], v[52:55], v[76:79]
  v_mfma_f32_16x16x32_bf16 v[92:95], v[116:119], v[52:55], v[92:95]
  v_mfma_f32_16x16x32_bf16 v[108:111], v[120:123], v[52:55], v[108:111]
  s_add_u32 s47, s43, 114688
  s_add_u32 s48, s44, 0
  s_mov_b32 m0, s48
  s_add_u32 s49, s47, 0
  buffer_load_dwordx4 v10, s[8:11], s49 offen lds
  s_add_u32 s48, s44, 1024
  s_mov_b32 m0, s48
  s_add_u32 s49, s47, 7168
  buffer_load_dwordx4 v10, s[8:11], s49 offen lds
  s_add_u32 s48, s44, 2048
  s_mov_b32 m0, s48
  s_add_u32 s49, s47, 14336
  buffer_load_dwordx4 v10, s[8:11], s49 offen lds
  s_add_u32 s48, s44, 3072
  s_mov_b32 m0, s48
  s_add_u32 s49, s47, 21504
  buffer_load_dwordx4 v10, s[8:11], s49 offen lds
  s_add_u32 s47, s45, 4096
  buffer_load_dwordx4 v[112:115], v11, s[16:19], s47 offen
  s_add_u32 s47, s47, 131072
  buffer_load_dwordx4 v[116:119], v11, s[16:19], s47 offen
  s_add_u32 s47, s47, 131072
  buffer_load_dwordx4 v[120:123], v11, s[16:19], s47 offen
  s_waitcnt vmcnt(21)
  ds_read_b64_tr_b16 v[40:41], v12 offset:4096
  ds_read_b64_tr_b16 v[42:43], v12 offset:6144
  ds_read_b64_tr_b16 v[44:45], v13 offset:4096
  ds_read_b64_tr_b16 v[46:47], v13 offset:6144
  ds_read_b64_tr_b16 v[48:49], v14 offset:4096
  ds_read_b64_tr_b16 v[50:51], v14 offset:6144
  ds_read_b64_tr_b16 v[52:53], v15 offset:4096
  ds_read_b64_tr_b16 v[54:55], v15 offset:6144
  s_waitcnt lgkmcnt(6)
  v_mfma_f32_16x16x32_bf16 v[64:67], v[124:127], v[40:43], v[64:67]
  v_mfma_f32_16x16x32_bf16 v[80:83], v[128:131], v[40:43], v[80:83]
  v_mfma_f32_16x16x32_bf16 v[96:99], v[132:135], v[40:43], v[96:99]
  s_waitcnt lgkmcnt(4)
  v_mfma_f32_16x16x32_bf16 v[68:71], v[124:127], v[44:47], v[68:71]
  v_mfma_f32_16x16x32_bf16 v[84:87], v[128:131], v[44:47], v[84:87]
  v_mfma_f32_16x16x32_bf16 v[100:103], v[132:135], v[44:47], v[100:103]
  s_waitcnt lgkmcnt(2)
  v_mfma_f32_16x16x32_bf16 v[72:75], v[124:127], v[48:51], v[72:75]
  v_mfma_f32_16x16x32_bf16 v[88:91], v[128:131], v[48:51], v[88:91]
  v_mfma_f32_16x16x32_bf16 v[104:107], v[132:135], v[48:51], v[104:107]
  s_waitcnt lgkmcnt(0)
  v_mfma_f32_16x16x32_bf16 v[76:79], v[124:127], v[52:55], v[76:79]
  v_mfma_f32_16x16x32_bf16 v[92:95], v[128:131], v[52:55], v[92:95]
  v_mfma_f32_16x16x32_bf16 v[108:111], v[132:135], v[52:55], v[108:111]
  s_add_u32 s47, s43, 143360
  s_add_u32 s48, s44, 4096
  s_mov_b32 m0, s48
  s_add_u32 s49, s47, 0
  buffer_load_dwordx4 v10, s[8:11], s49 offen lds
  s_add_u32 s48, s44, 5120
  s_mov_b32 m0, s48
  s_add_u32 s49, s47, 7168
  buffer_load_dwordx4 v10, s[8:11], s49 offen lds
  s_add_u32 s48, s44, 6144
  s_mov_b32 m0, s48
  s_add_u32 s49, s47, 14336
  buffer_load_dwordx4 v10, s[8:11], s49 offen lds
  s_add_u32 s48, s44, 7168
  s_mov_b32 m0, s48
  s_add_u32 s49, s47, 21504
  buffer_load_dwordx4 v10, s[8:11], s49 offen lds
  s_add_u32 s47, s45, 5120
  buffer_load_dwordx4 v[124:127], v11, s[16:19], s47 offen
  s_add_u32 s47, s47, 131072
  buffer_load_dwordx4 v[128:131], v11, s[16:19], s47 offen
  s_add_u32 s47, s47, 131072
  buffer_load_dwordx4 v[132:135], v11, s[16:19], s47 offen
  s_waitcnt vmcnt(21)
  ds_read_b64_tr_b16 v[40:41], v12 offset:8192
  ds_read_b64_tr_b16 v[42:43], v12 offset:10240
  ds_read_b64_tr_b16 v[44:45], v13 offset:8192
  ds_read_b64_tr_b16 v[46:47], v13 offset:10240
  ds_read_b64_tr_b16 v[48:49], v14 offset:8192
  ds_read_b64_tr_b16 v[50:51], v14 offset:10240
  ds_read_b64_tr_b16 v[52:53], v15 offset:8192
  ds_read_b64_tr_b16 v[54:55], v15 offset:10240
  s_waitcnt lgkmcnt(6)
  v_mfma_f32_16x16x32_bf16 v[64:67], v[136:139], v[40:43], v[64:67]
  v_mfma_f32_16x16x32_bf16 v[80:83], v[140:143], v[40:43], v[80:83]
  v_mfma_f32_16x16x32_bf16 v[96:99], v[144:147], v[40:43], v[96:99]
  s_waitcnt lgkmcnt(4)
  v_mfma_f32_16x16x32_bf16 v[68:71], v[136:139], v[44:47], v[68:71]
  v_mfma_f32_16x16x32_bf16 v[84:87], v[140:143], v[44:47], v[84:87]
  v_mfma_f32_16x16x32_bf16 v[100:103], v[144:147], v[44:47], v[100:103]
  s_waitcnt lgkmcnt(2)
  v_mfma_f32_16x16x32_bf16 v[72:75], v[136:139], v[48:51], v[72:75]
  v_mfma_f32_16x16x32_bf16 v[88:91], v[140:143], v[48:51], v[88:91]
  v_mfma_f32_16x16x32_bf16 v[104:107], v[144:147], v[48:51], v[104:107]
  s_waitcnt lgkmcnt(0)
  v_mfma_f32_16x16x32_bf16 v[76:79], v[136:139], v[52:55], v[76:79]
  v_mfma_f32_16x16x32_bf16 v[92:95], v[140:143], v[52:55], v[92:95]
  v_mfma_f32_16x16x32_bf16 v[108:111], v[144:147], v[52:55], v[108:111]
  s_add_u32 s47, s43, 172032
  s_add_u32 s48, s44, 8192
  s_mov_b32 m0, s48
  s_add_u32 s49, s47, 0
  buffer_load_dwordx4 v10, s[8:11], s49 offen lds
  s_add_u32 s48, s44, 9216
  s_mov_b32 m0, s48
  s_add_u32 s49, s47, 7168
  buffer_load_dwordx4 v10, s[8:11], s49 offen lds
  s_add_u32 s48, s44, 10240
  s_mov_b32 m0, s48
  s_add_u32 s49, s47, 14336
  buffer_load_dwordx4 v10, s[8:11], s49 offen lds
  s_add_u32 s48, s44, 11264
  s_mov_b32 m0, s48
  s_add_u32 s49, s47, 21504
  buffer_load_dwordx4 v10, s[8:11], s49 offen lds
  s_add_u32 s47, s45, 6144
  buffer_load_dwordx4 v[136:139], v11, s[16:19], s47 offen
  s_add_u32 s47, s47, 131072
  buffer_load_dwordx4 v[140:143], v11, s[16:19], s47 offen
  s_add_u32 s47, s47, 131072
  buffer_load_dwordx4 v[144:147], v11, s[16:19], s47 offen
  s_waitcnt vmcnt(21)
  ds_read_b64_tr_b16 v[40:41], v12 offset:12288
  ds_read_b64_tr_b16 v[42:43], v12 offset:14336
  ds_read_b64_tr_b16 v[44:45], v13 offset:12288
  ds_read_b64_tr_b16 v[46:47], v13 offset:14336
  ds_read_b64_tr_b16 v[48:49], v14 offset:12288
  ds_read_b64_tr_b16 v[50:51], v14 offset:14336
  ds_read_b64_tr_b16 v[52:53], v15 offset:12288
  ds_read_b64_tr_b16 v[54:55], v15 offset:14336
  s_waitcnt lgkmcnt(6)
  v_mfma_f32_16x16x32_bf16 v[64:67], v[148:151], v[40:43], v[64:67]
  v_mfma_f32_16x16x32_bf16 v[80:83], v[152:155], v[40:43], v[80:83]
  v_mfma_f32_16x16x32_bf16 v[96:99], v[156:159], v[40:43], v[96:99]
  s_waitcnt lgkmcnt(4)
  v_mfma_f32_16x16x32_bf16 v[68:71], v[148:151], v[44:47], v[68:71]
  v_mfma_f32_16x16x32_bf16 v[84:87], v[152:155], v[44:47], v[84:87]
  v_mfma_f32_16x16x32_bf16 v[100:103], v[156:159], v[44:47], v[100:103]
  s_waitcnt lgkmcnt(2)
  v_mfma_f32_16x16x32_bf16 v[72:75], v[148:151], v[48:51], v[72:75]
  v_mfma_f32_16x16x32_bf16 v[88:91], v[152:155], v[48:51], v[88:91]
  v_mfma_f32_16x16x32_bf16 v[104:107], v[156:159], v[48:51], v[104:107]
  s_waitcnt lgkmcnt(0)
  v_mfma_f32_16x16x32_bf16 v[76:79], v[148:151], v[52:55], v[76:79]
  v_mfma_f32_16x16x32_bf16 v[92:95], v[152:155], v[52:55], v[92:95]
  v_mfma_f32_16x16x32_bf16 v[108:111], v[156:159], v[52:55], v[108:111]
  s_add_u32 s47, s43, 200704
  s_add_u32 s48, s44, 12288
  s_mov_b32 m0, s48
  s_add_u32 s49, s47, 0
  buffer_load_dwordx4 v10, s[8:11], s49 offen lds
  s_add_u32 s48, s44, 13312
  s_mov_b32 m0, s48
  s_add_u32 s49, s47, 7168
  buffer_load_dwordx4 v10, s[8:11], s49 offen lds
  s_add_u32 s48, s44, 14336
  s_mov_b32 m0, s48
  s_add_u32 s49, s47, 14336
  buffer_load_dwordx4 v10, s[8:11], s49 offen lds
  s_add_u32 s48, s44, 15360
  s_mov_b32 m0, s48
  s_add_u32 s49, s47, 21504
  buffer_load_dwordx4 v10, s[8:11], s49 offen lds
  s_add_u32 s47, s45, 7168
  buffer_load_dwordx4 v[148:151], v11, s[16:19], s47 offen
  s_add_u32 s47, s47, 131072
  buffer_load_dwordx4 v[152:155], v11, s[16:19], s47 offen
  s_add_u32 s47, s47, 131072
  buffer_load_dwordx4 v[156:159], v11, s[16:19], s47 offen
  s_waitcnt vmcnt(21)
  ds_read_b64_tr_b16 v[40:41], v12 offset:0
  ds_read_b64_tr_b16 v[42:43], v12 offset:2048
  ds_read_b64_tr_b16 v[44:45], v13 offset:0
  ds_read_b64_tr_b16 v[46:47], v13 offset:2048
  ds_read_b64_tr_b16 v[48:49], v14 offset:0
  ds_read_b64_tr_b16 v[50:51], v14 offset:2048
  ds_read_b64_tr_b16 v[52:53], v15 offset:0
  ds_read_b64_tr_b16 v[54:55], v15 offset:2048
  s_waitcnt lgkmcnt(6)
  v_mfma_f32_16x16x32_bf16 v[64:67], v[112:115], v[40:43], v[64:67]
  v_mfma_f32_16x16x32_bf16 v[80:83], v[116:119], v[40:43], v[80:83]
  v_mfma_f32_16x16x32_bf16 v[96:99], v[120:123], v[40:43], v[96:99]
  s_waitcnt lgkmcnt(4)
  v_mfma_f32_16x16x32_bf16 v[68:71], v[112:115], v[44:47], v[68:71]
  v_mfma_f32_16x16x32_bf16 v[84:87], v[116:119], v[44:47], v[84:87]
  v_mfma_f32_16x16x32_bf16 v[100:103], v[120:123], v[44:47], v[100:103]
  s_waitcnt lgkmcnt(2)
  v_mfma_f32_16x16x32_bf16 v[72:75], v[112:115], v[48:51], v[72:75]
  v_mfma_f32_16x16x32_bf16 v[88:91], v[116:119], v[48:51], v[88:91]
  v_mfma_f32_16x16x32_bf16 v[104:107], v[120:123], v[48:51], v[104:107]
  s_waitcnt lgkmcnt(0)
  v_mfma_f32_16x16x32_bf16 v[76:79], v[112:115], v[52:55], v[76:79]
  v_mfma_f32_16x16x32_bf16 v[92:95], v[116:119], v[52:55], v[92:95]
  v_mfma_f32_16x16x32_bf16 v[108:111], v[120:123], v[52:55], v[108:111]
  s_add_u32 s47, s43, 229376
  s_add_u32 s48, s44, 0
  s_mov_b32 m0, s48
  s_add_u32 s49, s47, 0
  buffer_load_dwordx4 v10, s[8:11], s49 offen lds
  s_add_u32 s48, s44, 1024
  s_mov_b32 m0, s48
  s_add_u32 s49, s47, 7168
  buffer_load_dwordx4 v10, s[8:11], s49 offen lds
  s_add_u32 s48, s44, 2048
  s_mov_b32 m0, s48
  s_add_u32 s49, s47, 14336
  buffer_load_dwordx4 v10, s[8:11], s49 offen lds
  s_add_u32 s48, s44, 3072
  s_mov_b32 m0, s48
  s_add_u32 s49, s47, 21504
  buffer_load_dwordx4 v10, s[8:11], s49 offen lds
  s_add_u32 s47, s45, 8192
  buffer_load_dwordx4 v[112:115], v11, s[16:19], s47 offen
  s_add_u32 s47, s47, 131072
  buffer_load_dwordx4 v[116:119], v11, s[16:19], s47 offen
  s_add_u32 s47, s47, 131072
  buffer_load_dwordx4 v[120:123], v11, s[16:19], s47 offen
  s_waitcnt vmcnt(21)
  ds_read_b64_tr_b16 v[40:41], v12 offset:4096
  ds_read_b64_tr_b16 v[42:43], v12 offset:6144
  ds_read_b64_tr_b16 v[44:45], v13 offset:4096
  ds_read_b64_tr_b16 v[46:47], v13 offset:6144
  ds_read_b64_tr_b16 v[48:49], v14 offset:4096
  ds_read_b64_tr_b16 v[50:51], v14 offset:6144
  ds_read_b64_tr_b16 v[52:53], v15 offset:4096
  ds_read_b64_tr_b16 v[54:55], v15 offset:6144
  s_waitcnt lgkmcnt(6)
  v_mfma_f32_16x16x32_bf16 v[64:67], v[124:127], v[40:43], v[64:67]
  v_mfma_f32_16x16x32_bf16 v[80:83], v[128:131], v[40:43], v[80:83]
  v_mfma_f32_16x16x32_bf16 v[96:99], v[132:135], v[40:43], v[96:99]
  s_waitcnt lgkmcnt(4)
  v_mfma_f32_16x16x32_bf16 v[68:71], v[124:127], v[44:47], v[68:71]
  v_mfma_f32_16x16x32_bf16 v[84:87], v[128:131], v[44:47], v[84:87]
  v_mfma_f32_16x16x32_bf16 v[100:103], v[132:135], v[44:47], v[100:103]
  s_waitcnt lgkmcnt(2)
  v_mfma_f32_16x16x32_bf16 v[72:75], v[124:127], v[48:51], v[72:75]
  v_mfma_f32_16x16x32_bf16 v[88:91], v[128:131], v[48:51], v[88:91]
  v_mfma_f32_16x16x32_bf16 v[104:107], v[132:135], v[48:51], v[104:107]
  s_waitcnt lgkmcnt(0)
  v_mfma_f32_16x16x32_bf16 v[76:79], v[124:127], v[52:55], v[76:79]
  v_mfma_f32_16x16x32_bf16 v[92:95], v[128:131], v[52:55], v[92:95]
  v_mfma_f32_16x16x32_bf16 v[108:111], v[132:135], v[52:55], v[108:111]
  s_add_u32 s47, s43, 258048
  s_add_u32 s48, s44, 4096
  s_mov_b32 m0, s48
  s_add_u32 s49, s47, 0
  buffer_load_dwordx4 v10, s[8:11], s49 offen lds
  s_add_u32 s48, s44, 5120
  s_mov_b32 m0, s48
  s_add_u32 s49, s47, 7168
  buffer_load_dwordx4 v10, s[8:11], s49 offen lds
  s_add_u32 s48, s44, 6144
  s_mov_b32 m0, s48
  s_add_u32 s49, s47, 14336
  buffer_load_dwordx4 v10, s[8:11], s49 offen lds
  s_add_u32 s48, s44, 7168
  s_mov_b32 m0, s48
  s_add_u32 s49, s47, 21504
  buffer_load_dwordx4 v10, s[8:11], s49 offen lds
  s_add_u32 s47, s45, 9216
  buffer_load_dwordx4 v[124:127], v11, s[16:19], s47 offen
  s_add_u32 s47, s47, 131072
  buffer_load_dwordx4 v[128:131], v11, s[16:19], s47 offen
  s_add_u32 s47, s47, 131072
  buffer_load_dwordx4 v[132:135], v11, s[16:19], s47 offen
  s_waitcnt vmcnt(21)
  ds_read_b64_tr_b16 v[40:41], v12 offset:8192
  ds_read_b64_tr_b16 v[42:43], v12 offset:10240
  ds_read_b64_tr_b16 v[44:45], v13 offset:8192
  ds_read_b64_tr_b16 v[46:47], v13 offset:10240
  ds_read_b64_tr_b16 v[48:49], v14 offset:8192
  ds_read_b64_tr_b16 v[50:51], v14 offset:10240
  ds_read_b64_tr_b16 v[52:53], v15 offset:8192
  ds_read_b64_tr_b16 v[54:55], v15 offset:10240
  s_waitcnt lgkmcnt(6)
  v_mfma_f32_16x16x32_bf16 v[64:67], v[136:139], v[40:43], v[64:67]
  v_mfma_f32_16x16x32_bf16 v[80:83], v[140:143], v[40:43], v[80:83]
  v_mfma_f32_16x16x32_bf16 v[96:99], v[144:147], v[40:43], v[96:99]
  s_waitcnt lgkmcnt(4)
  v_mfma_f32_16x16x32_bf16 v[68:71], v[136:139], v[44:47], v[68:71]
  v_mfma_f32_16x16x32_bf16 v[84:87], v[140:143], v[44:47], v[84:87]
  v_mfma_f32_16x16x32_bf16 v[100:103], v[144:147], v[44:47], v[100:103]
  s_waitcnt lgkmcnt(2)
  v_mfma_f32_16x16x32_bf16 v[72:75], v[136:139], v[48:51], v[72:75]
  v_mfma_f32_16x16x32_bf16 v[88:91], v[140:143], v[48:51], v[88:91]
  v_mfma_f32_16x16x32_bf16 v[104:107], v[144:147], v[48:51], v[104:107]
  s_waitcnt lgkmcnt(0)
  v_mfma_f32_16x16x32_bf16 v[76:79], v[136:139], v[52:55], v[76:79]
  v_mfma_f32_16x16x32_bf16 v[92:95], v[140:143], v[52:55], v[92:95]
  v_mfma_f32_16x16x32_bf16 v[108:111], v[144:147], v[52:55], v[108:111]
  s_add_u32 s47, s43, 286720
  s_add_u32 s48, s44, 8192
  s_mov_b32 m0, s48
  s_add_u32 s49, s47, 0
  buffer_load_dwordx4 v10, s[8:11], s49 offen lds
  s_add_u32 s48, s44, 9216
  s_mov_b32 m0, s48
  s_add_u32 s49, s47, 7168
  buffer_load_dwordx4 v10, s[8:11], s49 offen lds
  s_add_u32 s48, s44, 10240
  s_mov_b32 m0, s48
  s_add_u32 s49, s47, 14336
  buffer_load_dwordx4 v10, s[8:11], s49 offen lds
  s_add_u32 s48, s44, 11264
  s_mov_b32 m0, s48
  s_add_u32 s49, s47, 21504
  buffer_load_dwordx4 v10, s[8:11], s49 offen lds
  s_add_u32 s47, s45, 10240
  buffer_load_dwordx4 v[136:139], v11, s[16:19], s47 offen
  s_add_u32 s47, s47, 131072
  buffer_load_dwordx4 v[140:143], v11, s[16:19], s47 offen
  s_add_u32 s47, s47, 131072
  buffer_load_dwordx4 v[144:147], v11, s[16:19], s47 offen
  s_waitcnt vmcnt(21)
  ds_read_b64_tr_b16 v[40:41], v12 offset:12288
  ds_read_b64_tr_b16 v[42:43], v12 offset:14336
  ds_read_b64_tr_b16 v[44:45], v13 offset:12288
  ds_read_b64_tr_b16 v[46:47], v13 offset:14336
  ds_read_b64_tr_b16 v[48:49], v14 offset:12288
  ds_read_b64_tr_b16 v[50:51], v14 offset:14336
  ds_read_b64_tr_b16 v[52:53], v15 offset:12288
  ds_read_b64_tr_b16 v[54:55], v15 offset:14336
  s_waitcnt lgkmcnt(6)
  v_mfma_f32_16x16x32_bf16 v[64:67], v[148:151], v[40:43], v[64:67]
  v_mfma_f32_16x16x32_bf16 v[80:83], v[152:155], v[40:43], v[80:83]
  v_mfma_f32_16x16x32_bf16 v[96:99], v[156:159], v[40:43], v[96:99]
  s_waitcnt lgkmcnt(4)
  v_mfma_f32_16x16x32_bf16 v[68:71], v[148:151], v[44:47], v[68:71]
  v_mfma_f32_16x16x32_bf16 v[84:87], v[152:155], v[44:47], v[84:87]
  v_mfma_f32_16x16x32_bf16 v[100:103], v[156:159], v[44:47], v[100:103]
  s_waitcnt lgkmcnt(2)
  v_mfma_f32_16x16x32_bf16 v[72:75], v[148:151], v[48:51], v[72:75]
  v_mfma_f32_16x16x32_bf16 v[88:91], v[152:155], v[48:51], v[88:91]
  v_mfma_f32_16x16x32_bf16 v[104:107], v[156:159], v[48:51], v[104:107]
  s_waitcnt lgkmcnt(0)
  v_mfma_f32_16x16x32_bf16 v[76:79], v[148:151], v[52:55], v[76:79]
  v_mfma_f32_16x16x32_bf16 v[92:95], v[152:155], v[52:55], v[92:95]
  v_mfma_f32_16x16x32_bf16 v[108:111], v[156:159], v[52:55], v[108:111]
  s_add_u32 s47, s43, 315392
  s_add_u32 s48, s44, 12288
  s_mov_b32 m0, s48
  s_add_u32 s49, s47, 0
  buffer_load_dwordx4 v10, s[8:11], s49 offen lds
  s_add_u32 s48, s44, 13312
  s_mov_b32 m0, s48
  s_add_u32 s49, s47, 7168
  buffer_load_dwordx4 v10, s[8:11], s49 offen lds
  s_add_u32 s48, s44, 14336
  s_mov_b32 m0, s48
  s_add_u32 s49, s47, 14336
  buffer_load_dwordx4 v10, s[8:11], s49 offen lds
  s_add_u32 s48, s44, 15360
  s_mov_b32 m0, s48
  s_add_u32 s49, s47, 21504
  buffer_load_dwordx4 v10, s[8:11], s49 offen lds
  s_add_u32 s47, s45, 11264
  buffer_load_dwordx4 v[148:151], v11, s[16:19], s47 offen
  s_add_u32 s47, s47, 131072
  buffer_load_dwordx4 v[152:155], v11, s[16:19], s47 offen
  s_add_u32 s47, s47, 131072
  buffer_load_dwordx4 v[156:159], v11, s[16:19], s47 offen
  s_waitcnt vmcnt(21)
  ds_read_b64_tr_b16 v[40:41], v12 offset:0
  ds_read_b64_tr_b16 v[42:43], v12 offset:2048
  ds_read_b64_tr_b16 v[44:45], v13 offset:0
  ds_read_b64_tr_b16 v[46:47], v13 offset:2048
  ds_read_b64_tr_b16 v[48:49], v14 offset:0
  ds_read_b64_tr_b16 v[50:51], v14 offset:2048
  ds_read_b64_tr_b16 v[52:53], v15 offset:0
  ds_read_b64_tr_b16 v[54:55], v15 offset:2048
  s_waitcnt lgkmcnt(6)
  v_mfma_f32_16x16x32_bf16 v[64:67], v[112:115], v[40:43], v[64:67]
  v_mfma_f32_16x16x32_bf16 v[80:83], v[116:119], v[40:43], v[80:83]
  v_mfma_f32_16x16x32_bf16 v[96:99], v[120:123], v[40:43], v[96:99]
  s_waitcnt lgkmcnt(4)
  v_mfma_f32_16x16x32_bf16 v[68:71], v[112:115], v[44:47], v[68:71]
  v_mfma_f32_16x16x32_bf16 v[84:87], v[116:119], v[44:47], v[84:87]
  v_mfma_f32_16x16x32_bf16 v[100:103], v[120:123], v[44:47], v[100:103]
  s_waitcnt lgkmcnt(2)
  v_mfma_f32_16x16x32_bf16 v[72:75], v[112:115], v[48:51], v[72:75]
  v_mfma_f32_16x16x32_bf16 v[88:91], v[116:119], v[48:51], v[88:91]
  v_mfma_f32_16x16x32_bf16 v[104:107], v[120:123], v[48:51], v[104:107]
  s_waitcnt lgkmcnt(0)
  v_mfma_f32_16x16x32_bf16 v[76:79], v[112:115], v[52:55], v[76:79]
  v_mfma_f32_16x16x32_bf16 v[92:95], v[116:119], v[52:55], v[92:95]
  v_mfma_f32_16x16x32_bf16 v[108:111], v[120:123], v[52:55], v[108:111]
  s_add_u32 s47, s43, 344064
  s_add_u32 s48, s44, 0
  s_mov_b32 m0, s48
  s_add_u32 s49, s47, 0
  buffer_load_dwordx4 v10, s[8:11], s49 offen lds
  s_add_u32 s48, s44, 1024
  s_mov_b32 m0, s48
  s_add_u32 s49, s47, 7168
  buffer_load_dwordx4 v10, s[8:11], s49 offen lds
  s_add_u32 s48, s44, 2048
  s_mov_b32 m0, s48
  s_add_u32 s49, s47, 14336
  buffer_load_dwordx4 v10, s[8:11], s49 offen lds
  s_add_u32 s48, s44, 3072
  s_mov_b32 m0, s48
  s_add_u32 s49, s47, 21504
  buffer_load_dwordx4 v10, s[8:11], s49 offen lds
  s_add_u32 s47, s45, 12288
  buffer_load_dwordx4 v[112:115], v11, s[16:19], s47 offen
  s_add_u32 s47, s47, 131072
  buffer_load_dwordx4 v[116:119], v11, s[16:19], s47 offen
  s_add_u32 s47, s47, 131072
  buffer_load_dwordx4 v[120:123], v11, s[16:19], s47 offen
  s_waitcnt vmcnt(21)
  ds_read_b64_tr_b16 v[40:41], v12 offset:4096
  ds_read_b64_tr_b16 v[42:43], v12 offset:6144
  ds_read_b64_tr_b16 v[44:45], v13 offset:4096
  ds_read_b64_tr_b16 v[46:47], v13 offset:6144
  ds_read_b64_tr_b16 v[48:49], v14 offset:4096
  ds_read_b64_tr_b16 v[50:51], v14 offset:6144
  ds_read_b64_tr_b16 v[52:53], v15 offset:4096
  ds_read_b64_tr_b16 v[54:55], v15 offset:6144
  s_waitcnt lgkmcnt(6)
  v_mfma_f32_16x16x32_bf16 v[64:67], v[124:127], v[40:43], v[64:67]
  v_mfma_f32_16x16x32_bf16 v[80:83], v[128:131], v[40:43], v[80:83]
  v_mfma_f32_16x16x32_bf16 v[96:99], v[132:135], v[40:43], v[96:99]
  s_waitcnt lgkmcnt(4)
  v_mfma_f32_16x16x32_bf16 v[68:71], v[124:127], v[44:47], v[68:71]
  v_mfma_f32_16x16x32_bf16 v[84:87], v[128:131], v[44:47], v[84:87]
  v_mfma_f32_16x16x32_bf16 v[100:103], v[132:135], v[44:47], v[100:103]
  s_waitcnt lgkmcnt(2)
  v_mfma_f32_16x16x32_bf16 v[72:75], v[124:127], v[48:51], v[72:75]
  v_mfma_f32_16x16x32_bf16 v[88:91], v[128:131], v[48:51], v[88:91]
  v_mfma_f32_16x16x32_bf16 v[104:107], v[132:135], v[48:51], v[104:107]
  s_waitcnt lgkmcnt(0)
  v_mfma_f32_16x16x32_bf16 v[76:79], v[124:127], v[52:55], v[76:79]
  v_mfma_f32_16x16x32_bf16 v[92:95], v[128:131], v[52:55], v[92:95]
  v_mfma_f32_16x16x32_bf16 v[108:111], v[132:135], v[52:55], v[108:111]
  s_add_u32 s47, s43, 372736
  s_add_u32 s48, s44, 4096
  s_mov_b32 m0, s48
  s_add_u32 s49, s47, 0
  buffer_load_dwordx4 v10, s[8:11], s49 offen lds
  s_add_u32 s48, s44, 5120
  s_mov_b32 m0, s48
  s_add_u32 s49, s47, 7168
  buffer_load_dwordx4 v10, s[8:11], s49 offen lds
  s_add_u32 s48, s44, 6144
  s_mov_b32 m0, s48
  s_add_u32 s49, s47, 14336
  buffer_load_dwordx4 v10, s[8:11], s49 offen lds
  s_add_u32 s48, s44, 7168
  s_mov_b32 m0, s48
  s_add_u32 s49, s47, 21504
  buffer_load_dwordx4 v10, s[8:11], s49 offen lds
  s_add_u32 s47, s45, 13312
  buffer_load_dwordx4 v[124:127], v11, s[16:19], s47 offen
  s_add_u32 s47, s47, 131072
  buffer_load_dwordx4 v[128:131], v11, s[16:19], s47 offen
  s_add_u32 s47, s47, 131072
  buffer_load_dwordx4 v[132:135], v11, s[16:19], s47 offen
  s_waitcnt vmcnt(21)
  ds_read_b64_tr_b16 v[40:41], v12 offset:8192
  ds_read_b64_tr_b16 v[42:43], v12 offset:10240
  ds_read_b64_tr_b16 v[44:45], v13 offset:8192
  ds_read_b64_tr_b16 v[46:47], v13 offset:10240
  ds_read_b64_tr_b16 v[48:49], v14 offset:8192
  ds_read_b64_tr_b16 v[50:51], v14 offset:10240
  ds_read_b64_tr_b16 v[52:53], v15 offset:8192
  ds_read_b64_tr_b16 v[54:55], v15 offset:10240
  s_waitcnt lgkmcnt(6)
  v_mfma_f32_16x16x32_bf16 v[64:67], v[136:139], v[40:43], v[64:67]
  v_mfma_f32_16x16x32_bf16 v[80:83], v[140:143], v[40:43], v[80:83]
  v_mfma_f32_16x16x32_bf16 v[96:99], v[144:147], v[40:43], v[96:99]
  s_waitcnt lgkmcnt(4)
  v_mfma_f32_16x16x32_bf16 v[68:71], v[136:139], v[44:47], v[68:71]
  v_mfma_f32_16x16x32_bf16 v[84:87], v[140:143], v[44:47], v[84:87]
  v_mfma_f32_16x16x32_bf16 v[100:103], v[144:147], v[44:47], v[100:103]
  s_waitcnt lgkmcnt(2)
  v_mfma_f32_16x16x32_bf16 v[72:75], v[136:139], v[48:51], v[72:75]
  v_mfma_f32_16x16x32_bf16 v[88:91], v[140:143], v[48:51], v[88:91]
  v_mfma_f32_16x16x32_bf16 v[104:107], v[144:147], v[48:51], v[104:107]
  s_waitcnt lgkmcnt(0)
  v_mfma_f32_16x16x32_bf16 v[76:79], v[136:139], v[52:55], v[76:79]
  v_mfma_f32_16x16x32_bf16 v[92:95], v[140:143], v[52:55], v[92:95]
  v_mfma_f32_16x16x32_bf16 v[108:111], v[144:147], v[52:55], v[108:111]
  s_add_u32 s47, s43, 401408
  s_add_u32 s48, s44, 8192
  s_mov_b32 m0, s48
  s_add_u32 s49, s47, 0
  buffer_load_dwordx4 v10, s[8:11], s49 offen lds
  s_add_u32 s48, s44, 9216
  s_mov_b32 m0, s48
  s_add_u32 s49, s47, 7168
  buffer_load_dwordx4 v10, s[8:11], s49 offen lds
  s_add_u32 s48, s44, 10240
  s_mov_b32 m0, s48
  s_add_u32 s49, s47, 14336
  buffer_load_dwordx4 v10, s[8:11], s49 offen lds
  s_add_u32 s48, s44, 11264
  s_mov_b32 m0, s48
  s_add_u32 s49, s47, 21504
  buffer_load_dwordx4 v10, s[8:11], s49 offen lds
  s_add_u32 s47, s45, 14336
  buffer_load_dwordx4 v[136:139], v11, s[16:19], s47 offen
  s_add_u32 s47, s47, 131072
  buffer_load_dwordx4 v[140:143], v11, s[16:19], s47 offen
  s_add_u32 s47, s47, 131072
  buffer_load_dwordx4 v[144:147], v11, s[16:19], s47 offen
  s_waitcnt vmcnt(21)
  ds_read_b64_tr_b16 v[40:41], v12 offset:12288
  ds_read_b64_tr_b16 v[42:43], v12 offset:14336
  ds_read_b64_tr_b16 v[44:45], v13 offset:12288
  ds_read_b64_tr_b16 v[46:47], v13 offset:14336
  ds_read_b64_tr_b16 v[48:49], v14 offset:12288
  ds_read_b64_tr_b16 v[50:51], v14 offset:14336
  ds_read_b64_tr_b16 v[52:53], v15 offset:12288
  ds_read_b64_tr_b16 v[54:55], v15 offset:14336
  s_waitcnt lgkmcnt(6)
  v_mfma_f32_16x16x32_bf16 v[64:67], v[148:151], v[40:43], v[64:67]
  v_mfma_f32_16x16x32_bf16 v[80:83], v[152:155], v[40:43], v[80:83]
  v_mfma_f32_16x16x32_bf16 v[96:99], v[156:159], v[40:43], v[96:99]
  s_waitcnt lgkmcnt(4)
  v_mfma_f32_16x16x32_bf16 v[68:71], v[148:151], v[44:47], v[68:71]
  v_mfma_f32_16x16x32_bf16 v[84:87], v[152:155], v[44:47], v[84:87]
  v_mfma_f32_16x16x32_bf16 v[100:103], v[156:159], v[44:47], v[100:103]
  s_waitcnt lgkmcnt(2)
  v_mfma_f32_16x16x32_bf16 v[72:75], v[148:151], v[48:51], v[72:75]
  v_mfma_f32_16x16x32_bf16 v[88:91], v[152:155], v[48:51], v[88:91]
  v_mfma_f32_16x16x32_bf16 v[104:107], v[156:159], v[48:51], v[104:107]
  s_waitcnt lgkmcnt(0)
  v_mfma_f32_16x16x32_bf16 v[76:79], v[148:151], v[52:55], v[76:79]
  v_mfma_f32_16x16x32_bf16 v[92:95], v[152:155], v[52:55], v[92:95]
  v_mfma_f32_16x16x32_bf16 v[108:111], v[156:159], v[52:55], v[108:111]
  s_add_u32 s47, s43, 430080
  s_add_u32 s48, s44, 12288
  s_mov_b32 m0, s48
  s_add_u32 s49, s47, 0
  buffer_load_dwordx4 v10, s[8:11], s49 offen lds
  s_add_u32 s48, s44, 13312
  s_mov_b32 m0, s48
  s_add_u32 s49, s47, 7168
  buffer_load_dwordx4 v10, s[8:11], s49 offen lds
  s_add_u32 s48, s44, 14336
  s_mov_b32 m0, s48
  s_add_u32 s49, s47, 14336
  buffer_load_dwordx4 v10, s[8:11], s49 offen lds
  s_add_u32 s48, s44, 15360
  s_mov_b32 m0, s48
  s_add_u32 s49, s47, 21504
  buffer_load_dwordx4 v10, s[8:11], s49 offen lds
  s_add_u32 s47, s45, 15360
  buffer_load_dwordx4 v[148:151], v11, s[16:19], s47 offen
  s_add_u32 s47, s47, 131072
  buffer_load_dwordx4 v[152:155], v11, s[16:19], s47 offen
  s_add_u32 s47, s47, 131072
  buffer_load_dwordx4 v[156:159], v11, s[16:19], s47 offen
  s_waitcnt vmcnt(21)
  ds_read_b64_tr_b16 v[40:41], v12 offset:0
  ds_read_b64_tr_b16 v[42:43], v12 offset:2048
  ds_read_b64_tr_b16 v[44:45], v13 offset:0
  ds_read_b64_tr_b16 v[46:47], v13 offset:2048
  ds_read_b64_tr_b16 v[48:49], v14 offset:0
  ds_read_b64_tr_b16 v[50:51], v14 offset:2048
  ds_read_b64_tr_b16 v[52:53], v15 offset:0
  ds_read_b64_tr_b16 v[54:55], v15 offset:2048
  s_waitcnt lgkmcnt(6)
  v_mfma_f32_16x16x32_bf16 v[64:67], v[112:115], v[40:43], v[64:67]
  v_mfma_f32_16x16x32_bf16 v[80:83], v[116:119], v[40:43], v[80:83]
  v_mfma_f32_16x16x32_bf16 v[96:99], v[120:123], v[40:43], v[96:99]
  s_waitcnt lgkmcnt(4)
  v_mfma_f32_16x16x32_bf16 v[68:71], v[112:115], v[44:47], v[68:71]
  v_mfma_f32_16x16x32_bf16 v[84:87], v[116:119], v[44:47], v[84:87]
  v_mfma_f32_16x16x32_bf16 v[100:103], v[120:123], v[44:47], v[100:103]
  s_waitcnt lgkmcnt(2)
  v_mfma_f32_16x16x32_bf16 v[72:75], v[112:115], v[48:51], v[72:75]
  v_mfma_f32_16x16x32_bf16 v[88:91], v[116:119], v[48:51], v[88:91]
  v_mfma_f32_16x16x32_bf16 v[104:107], v[120:123], v[48:51], v[104:107]
  s_waitcnt lgkmcnt(0)
  v_mfma_f32_16x16x32_bf16 v[76:79], v[112:115], v[52:55], v[76:79]
  v_mfma_f32_16x16x32_bf16 v[92:95], v[116:119], v[52:55], v[92:95]
  v_mfma_f32_16x16x32_bf16 v[108:111], v[120:123], v[52:55], v[108:111]
  s_waitcnt vmcnt(14)
  ds_read_b64_tr_b16 v[40:41], v12 offset:4096
  ds_read_b64_tr_b16 v[42:43], v12 offset:6144
  ds_read_b64_tr_b16 v[44:45], v13 offset:4096
  ds_read_b64_tr_b16 v[46:47], v13 offset:6144
  ds_read_b64_tr_b16 v[48:49], v14 offset:4096
  ds_read_b64_tr_b16 v[50:51], v14 offset:6144
  ds_read_b64_tr_b16 v[52:53], v15 offset:4096
  ds_read_b64_tr_b16 v[54:55], v15 offset:6144
  s_waitcnt lgkmcnt(6)
  v_mfma_f32_16x16x32_bf16 v[64:67], v[124:127], v[40:43], v[64:67]
  v_mfma_f32_16x16x32_bf16 v[80:83], v[128:131], v[40:43], v[80:83]
  v_mfma_f32_16x16x32_bf16 v[96:99], v[132:135], v[40:43], v[96:99]
  s_waitcnt lgkmcnt(4)
  v_mfma_f32_16x16x32_bf16 v[68:71], v[124:127], v[44:47], v[68:71]
  v_mfma_f32_16x16x32_bf16 v[84:87], v[128:131], v[44:47], v[84:87]
  v_mfma_f32_16x16x32_bf16 v[100:103], v[132:135], v[44:47], v[100:103]
  s_waitcnt lgkmcnt(2)
  v_mfma_f32_16x16x32_bf16 v[72:75], v[124:127], v[48:51], v[72:75]
  v_mfma_f32_16x16x32_bf16 v[88:91], v[128:131], v[48:51], v[88:91]
  v_mfma_f32_16x16x32_bf16 v[104:107], v[132:135], v[48:51], v[104:107]
  s_waitcnt lgkmcnt(0)
  v_mfma_f32_16x16x32_bf16 v[76:79], v[124:127], v[52:55], v[76:79]
  v_mfma_f32_16x16x32_bf16 v[92:95], v[128:131], v[52:55], v[92:95]
  v_mfma_f32_16x16x32_bf16 v[108:111], v[132:135], v[52:55], v[108:111]
  s_waitcnt vmcnt(7)
  ds_read_b64_tr_b16 v[40:41], v12 offset:8192
  ds_read_b64_tr_b16 v[42:43], v12 offset:10240
  ds_read_b64_tr_b16 v[44:45], v13 offset:8192
  ds_read_b64_tr_b16 v[46:47], v13 offset:10240
  ds_read_b64_tr_b16 v[48:49], v14 offset:8192
  ds_read_b64_tr_b16 v[50:51], v14 offset:10240
  ds_read_b64_tr_b16 v[52:53], v15 offset:8192
  ds_read_b64_tr_b16 v[54:55], v15 offset:10240
  s_waitcnt lgkmcnt(6)
  v_mfma_f32_16x16x32_bf16 v[64:67], v[136:139], v[40:43], v[64:67]
  v_mfma_f32_16x16x32_bf16 v[80:83], v[140:143], v[40:43], v[80:83]
  v_mfma_f32_16x16x32_bf16 v[96:99], v[144:147], v[40:43], v[96:99]
  s_waitcnt lgkmcnt(4)
  v_mfma_f32_16x16x32_bf16 v[68:71], v[136:139], v[44:47], v[68:71]
  v_mfma_f32_16x16x32_bf16 v[84:87], v[140:143], v[44:47], v[84:87]
  v_mfma_f32_16x16x32_bf16 v[100:103], v[144:147], v[44:47], v[100:103]
  s_waitcnt lgkmcnt(2)
  v_mfma_f32_16x16x32_bf16 v[72:75], v[136:139], v[48:51], v[72:75]
  v_mfma_f32_16x16x32_bf16 v[88:91], v[140:143], v[48:51], v[88:91]
  v_mfma_f32_16x16x32_bf16 v[104:107], v[144:147], v[48:51], v[104:107]
  s_waitcnt lgkmcnt(0)
  v_mfma_f32_16x16x32_bf16 v[76:79], v[136:139], v[52:55], v[76:79]
  v_mfma_f32_16x16x32_bf16 v[92:95], v[140:143], v[52:55], v[92:95]
  v_mfma_f32_16x16x32_bf16 v[108:111], v[144:147], v[52:55], v[108:111]
  s_waitcnt vmcnt(0)
  ds_read_b64_tr_b16 v[40:41], v12 offset:12288
  ds_read_b64_tr_b16 v[42:43], v12 offset:14336
  ds_read_b64_tr_b16 v[44:45], v13 offset:12288
  ds_read_b64_tr_b16 v[46:47], v13 offset:14336
  ds_read_b64_tr_b16 v[48:49], v14 offset:12288
  ds_read_b64_tr_b16 v[50:51], v14 offset:14336
  ds_read_b64_tr_b16 v[52:53], v15 offset:12288
  ds_read_b64_tr_b16 v[54:55], v15 offset:14336
  s_waitcnt lgkmcnt(6)
  v_mfma_f32_16x16x32_bf16 v[64:67], v[148:151], v[40:43], v[64:67]
  v_mfma_f32_16x16x32_bf16 v[80:83], v[152:155], v[40:43], v[80:83]
  v_mfma_f32_16x16x32_bf16 v[96:99], v[156:159], v[40:43], v[96:99]
  s_waitcnt lgkmcnt(4)
  v_mfma_f32_16x16x32_bf16 v[68:71], v[148:151], v[44:47], v[68:71]
  v_mfma_f32_16x16x32_bf16 v[84:87], v[152:155], v[44:47], v[84:87]
  v_mfma_f32_16x16x32_bf16 v[100:103], v[156:159], v[44:47], v[100:103]
  s_waitcnt lgkmcnt(2)
  v_mfma_f32_16x16x32_bf16 v[72:75], v[148:151], v[48:51], v[72:75]
  v_mfma_f32_16x16x32_bf16 v[88:91], v[152:155], v[48:51], v[88:91]
  v_mfma_f32_16x16x32_bf16 v[104:107], v[156:159], v[48:51], v[104:107]
  s_waitcnt lgkmcnt(0)
  v_mfma_f32_16x16x32_bf16 v[76:79], v[148:151], v[52:55], v[76:79]
  v_mfma_f32_16x16x32_bf16 v[92:95], v[152:155], v[52:55], v[92:95]
  v_mfma_f32_16x16x32_bf16 v[108:111], v[156:159], v[52:55], v[108:111]
  s_nop 7
  s_nop 1
  s_barrier
  s_mul_i32 s47, s34, 12288
  v_add_u32 v4, s47, v11
  ds_write_b128 v4, v[64:67] offset:0
  ds_write_b128 v4, v[68:71] offset:1024
  ds_write_b128 v4, v[72:75] offset:2048
  ds_write_b128 v4, v[76:79] offset:3072
  ds_write_b128 v4, v[80:83] offset:4096
  ds_write_b128 v4, v[84:87] offset:5120
  ds_write_b128 v4, v[88:91] offset:6144
  ds_write_b128 v4, v[92:95] offset:7168
  ds_write_b128 v4, v[96:99] offset:8192
  ds_write_b128 v4, v[100:103] offset:9216
  ds_write_b128 v4, v[104:107] offset:10240
  ds_write_b128 v4, v[108:111] offset:11264
  s_waitcnt lgkmcnt(0)
  s_barrier
  s_cmp_ge_u32 s34, 6
  s_cbranch_scc1 K2_END
  s_lshl_b32 s47, s34, 11
  v_add_u32 v4, s47, v11
  v_add_u32 v16, 49152, v4
  v_lshlrev_b32 v5, 2, v3
  s_mul_i32 s47, s33, 48
  v_add_u32 v5, s47, v5
  v_mul_u32_u24 v5, 1792, v5
  v_lshl_add_u32 v5, v2, 1, v5
  s_mul_i32 s47, s32, 896
  s_lshl_b32 s48, s31, 7
  s_add_u32 s47, s47, s48
  s_lshr_b32 s48, s34, 1
  s_mul_i32 s48, s48, 28672
  s_add_u32 s47, s47, s48
  s_and_b32 s48, s34, 1
  s_lshl_b32 s48, s48, 6
  s_add_u32 s47, s47, s48
  s_add_u32 s50, s47, 0
  s_add_u32 s51, s47, 1792
  s_add_u32 s52, s47, 3584
  s_add_u32 s53, s47, 5376
  ds_read_b128 v[20:23], v4 offset:0
  ds_read_b128 v[24:27], v4 offset:12288
  ds_read_b128 v[28:31], v4 offset:24576
  ds_read_b128 v[32:35], v4 offset:36864
  ds_read_b128 v[36:39], v16 offset:0
  ds_read_b128 v[40:43], v16 offset:12288
  ds_read_b128 v[44:47], v16 offset:24576
  ds_read_b128 v[48:51], v16 offset:36864
  s_waitcnt lgkmcnt(0)
  v_add_f32 v20, v20, v24
  v_add_f32 v21, v21, v25
  v_add_f32 v22, v22, v26
  v_add_f32 v23, v23, v27
  v_add_f32 v20, v20, v28
  v_add_f32 v21, v21, v29
  v_add_f32 v22, v22, v30
  v_add_f32 v23, v23, v31
  v_add_f32 v20, v20, v32
  v_add_f32 v21, v21, v33
  v_add_f32 v22, v22, v34
  v_add_f32 v23, v23, v35
  v_add_f32 v20, v20, v36
  v_add_f32 v21, v21, v37
  v_add_f32 v22, v22, v38
  v_add_f32 v23, v23, v39
  v_add_f32 v20, v20, v40
  v_add_f32 v21, v21, v41
  v_add_f32 v22, v22, v42
  v_add_f32 v23, v23, v43
  v_add_f32 v20, v20, v44
  v_add_f32 v21, v21, v45
  v_add_f32 v22, v22, v46
  v_add_f32 v23, v23, v47
  v_add_f32 v20, v20, v48
  v_add_f32 v21, v21, v49
  v_add_f32 v22, v22, v50
  v_add_f32 v23, v23, v51
  v_cvt_pk_bf16_f32 v6, v20, v21
  v_cvt_pk_bf16_f32 v7, v22, v23
  v_lshrrev_b32 v8, 16, v6
  v_lshrrev_b32 v9, 16, v7
  buffer_store_short v6, v5, s[12:15], s50 offen offset:0
  buffer_store_short v8, v5, s[12:15], s51 offen offset:0
  buffer_store_short v7, v5, s[12:15], s52 offen offset:0
  buffer_store_short v9, v5, s[12:15], s53 offen offset:0
  ds_read_b128 v[20:23], v4 offset:1024
  ds_read_b128 v[24:27], v4 offset:13312
  ds_read_b128 v[28:31], v4 offset:25600
  ds_read_b128 v[32:35], v4 offset:37888
  ds_read_b128 v[36:39], v16 offset:1024
  ds_read_b128 v[40:43], v16 offset:13312
  ds_read_b128 v[44:47], v16 offset:25600
  ds_read_b128 v[48:51], v16 offset:37888
  s_waitcnt lgkmcnt(0)
  v_add_f32 v20, v20, v24
  v_add_f32 v21, v21, v25
  v_add_f32 v22, v22, v26
  v_add_f32 v23, v23, v27
  v_add_f32 v20, v20, v28
  v_add_f32 v21, v21, v29
  v_add_f32 v22, v22, v30
  v_add_f32 v23, v23, v31
  v_add_f32 v20, v20, v32
  v_add_f32 v21, v21, v33
  v_add_f32 v22, v22, v34
  v_add_f32 v23, v23, v35
  v_add_f32 v20, v20, v36
  v_add_f32 v21, v21, v37
  v_add_f32 v22, v22, v38
  v_add_f32 v23, v23, v39
  v_add_f32 v20, v20, v40
  v_add_f32 v21, v21, v41
  v_add_f32 v22, v22, v42
  v_add_f32 v23, v23, v43
  v_add_f32 v20, v20, v44
  v_add_f32 v21, v21, v45
  v_add_f32 v22, v22, v46
  v_add_f32 v23, v23, v47
  v_add_f32 v20, v20, v48
  v_add_f32 v21, v21, v49
  v_add_f32 v22, v22, v50
  v_add_f32 v23, v23, v51
  v_cvt_pk_bf16_f32 v6, v20, v21
  v_cvt_pk_bf16_f32 v7, v22, v23
  v_lshrrev_b32 v8, 16, v6
  v_lshrrev_b32 v9, 16, v7
  buffer_store_short v6, v5, s[12:15], s50 offen offset:32
  buffer_store_short v8, v5, s[12:15], s51 offen offset:32
  buffer_store_short v7, v5, s[12:15], s52 offen offset:32
  buffer_store_short v9, v5, s[12:15], s53 offen offset:32
K2_END:
  s_endpgm
.section .rodata,"a"
.p2align 6
.amdhsa_kernel attn_kernel
  .amdhsa_next_free_vgpr 160
  .amdhsa_next_free_sgpr 102
  .amdhsa_accum_offset 160
  .amdhsa_group_segment_fixed_size 0
  .amdhsa_kernarg_size 104
  .amdhsa_user_sgpr_count 2
  .amdhsa_user_sgpr_kernarg_segment_ptr 1
  .amdhsa_system_sgpr_workgroup_id_x 1
.end_amdhsa_kernel
.p2align 6
.amdhsa_kernel oproj_kernel
  .amdhsa_next_free_vgpr 160
  .amdhsa_next_free_sgpr 102
  .amdhsa_accum_offset 160
  .amdhsa_group_segment_fixed_size 0
  .amdhsa_kernarg_size 104
  .amdhsa_user_sgpr_count 2
  .amdhsa_user_sgpr_kernarg_segment_ptr 1
  .amdhsa_system_sgpr_workgroup_id_x 1
.end_amdhsa_kernel
```
